```python
import torch

def _softmax(x, axis=-1):
    return torch.softmax(x, dim=axis)
def _gelu(x):
    return torch.nn.functional.gelu(x, approximate="tanh")
def _silu(x):
    return torch.nn.functional.silu(x)
def _sigmoid(x):
    return torch.sigmoid(x)
def _layernorm(x, axis=-1, eps=1e-5):
    m = x.mean(dim=axis, keepdim=True)
    v = x.var(dim=axis, keepdim=True, unbiased=False)
    return (x - m) / torch.sqrt(v + eps)
def _scatter_add(tgt, idx, src, axis=0):
    return tgt.clone().index_add_(axis, idx, src)
def _segment_sum(src, seg, n):
    out = torch.zeros((n,) + src.shape[1:], dtype=src.dtype)
    return out.index_add_(0, seg, src)
def _pad(x, pw):
    flat = tuple(v for pair in reversed(pw) for v in pair)
    return torch.nn.functional.pad(x, flat)

kernel_name = 'sequential_preLN__spectral_gfnet__glu_gated_glu__prompt'

def setup_inputs():

    _w = (lambda a: (lambda t: t.to(torch.bfloat16) if t.is_floating_point() else t)(torch.as_tensor(a)))
    def _A_setup():
        B, S, D = 1, 2048, 448
        Df = D // 2 + 1
        return {
            "x": _w((lambda *s: torch.randn(*s, dtype=torch.bfloat16) * 0.05)(B, S, D)),
            "w_r": _w((lambda *s: torch.randn(*s, dtype=torch.bfloat16) * 0.4)(S, Df) * 0.02),
            "w_i": _w((lambda *s: torch.randn(*s, dtype=torch.bfloat16) * 0.4)(S, Df) * 0.02),
        }
    _A_in = _A_setup()

    def _B_setup():
        B, S, D, F = 1, 2048, 448, 1792
        return {
            "x": _w((lambda *s: torch.randn(*s, dtype=torch.bfloat16) * 0.05)(B, S, D)),
            "w_gate": _w((lambda *s: torch.randn(*s, dtype=torch.bfloat16) * 0.05)(D, F)),
            "w_up": _w((lambda *s: torch.randn(*s, dtype=torch.bfloat16) * 0.05)(D, F)),
            "w_down": _w((lambda *s: torch.randn(*s, dtype=torch.bfloat16) * 0.05)(F, D)),
        }
    _B_in = _B_setup()

    return {
        "A_x": _A_in["x"],
        "A_w_r": _A_in["w_r"],
        "A_w_i": _A_in["w_i"],
        "B_x": _B_in["x"],
        "B_w_gate": _B_in["w_gate"],
        "B_w_up": _B_in["w_up"],
        "B_w_down": _B_in["w_down"],
    }

def reference(A_x, A_w_r, A_w_i, B_x, B_w_gate, B_w_up, B_w_down):
    def _A_ref(x, w_r, w_i):
        B, S, D = x.shape
        X = (lambda x, axes=(-2,-1): torch.fft.rfft2(x.float(), dim=axes))(x, axes=(-2, -1))
        W = w_r + 1j * w_i
        X = X * W
        y = (lambda x, s, axes=(-2,-1): torch.fft.irfft2(x, s=s, dim=axes).to(torch.bfloat16))(X, (S, D), axes=(-2, -1))
        return y

    def _B_ref(x, w_gate, w_up, w_down):
        g = torch.einsum("bsd,df->bsf", x, w_gate)
        u = torch.einsum("bsd,df->bsf", x, w_up)
        h = _sigmoid(g) * u
        return torch.einsum("bsf,fd->bsd", h, w_down)

    x = A_x
    h = x + _A_ref(_layernorm(x, axis=-1), A_w_r, A_w_i)
    h2 = h + _B_ref(_layernorm(h, axis=-1), B_w_gate, B_w_up, B_w_down)
    return h2
```

```asm
; @launch grid=(256,1,1) block=(256,1,1) lds=115712
.amdgcn_target "amdgcn-amd-amdhsa--gfx950"
.text
.globl sequential_preLN__spectral_gfnet__glu_gated_glu__prompt_kernel
.p2align 8
.type sequential_preLN__spectral_gfnet__glu_gated_glu__prompt_kernel,@function
sequential_preLN__spectral_gfnet__glu_gated_glu__prompt_kernel:
    s_cmp_ge_u32 s2, 256
    s_cbranch_scc1 K3_END
    s_load_dwordx2 s[4:5], s[0:1], 0
    s_load_dwordx2 s[6:7], s[0:1], 72
    s_load_dwordx4 s[56:59], s[0:1], 8
    s_load_dwordx4 s[40:43], s[0:1], 32
    s_load_dwordx2 s[44:45], s[0:1], 48
    s_load_dwordx2 s[100:101], s[0:1], 64
    s_memrealtime s[98:99]
    v_lshrrev_b32 v1, 6, v0
    s_nop 0
    v_readfirstlane_b32 s3, v1
    v_and_b32 v1, 63, v0
    v_and_b32 v2, 15, v0
    v_lshrrev_b32 v3, 4, v1
    s_lshr_b32 s8, s2, 6
    s_lshl_b32 s8, s8, 4
    s_and_b32 s10, s2, 7
    s_lshl_b32 s10, s10, 1
    s_add_u32 s8, s8, s10
    s_bfe_u32 s10, s2, 0x10005
    s_add_u32 s8, s8, s10
    v_mul_u32_u24 v4, 57344, v2
    v_lshl_add_u32 v4, v3, 4, v4
    s_mul_i32 s20, s8, 896
    s_lshr_b32 s21, s3, 1
    s_mul_i32 s21, s21, 917504
    s_add_u32 s20, s20, s21
    s_and_b32 s21, s3, 1
    s_mul_i32 s21, s21, 448
    s_add_u32 s20, s20, s21
    s_mul_i32 s21, s3, 7168
    s_waitcnt lgkmcnt(0)
    s_mov_b32 s12, s4
    s_mov_b32 s13, s5
    s_mov_b32 s14, 1835008
    s_mov_b32 s15, 0x00020000
    s_add_u32 m0, s21, 0
    s_nop 0
    buffer_load_dwordx4 v4, s[12:15], s20 offen offset:0 lds
    s_add_u32 m0, s21, 960
    s_nop 0
    buffer_load_dwordx4 v4, s[12:15], s20 offen offset:64 lds
    s_add_u32 m0, s21, 1920
    s_nop 0
    buffer_load_dwordx4 v4, s[12:15], s20 offen offset:128 lds
    s_add_u32 m0, s21, 2880
    s_nop 0
    buffer_load_dwordx4 v4, s[12:15], s20 offen offset:192 lds
    s_add_u32 m0, s21, 3840
    s_nop 0
    buffer_load_dwordx4 v4, s[12:15], s20 offen offset:256 lds
    s_add_u32 m0, s21, 4800
    s_nop 0
    buffer_load_dwordx4 v4, s[12:15], s20 offen offset:320 lds
    s_add_u32 m0, s21, 5760
    s_nop 0
    buffer_load_dwordx4 v4, s[12:15], s20 offen offset:384 lds
    s_cmp_lg_u32 s3, 3
    s_cbranch_scc1 CPF_X
    s_lshr_b32 s97, s2, 3
    s_cmp_ge_u32 s97, 4
    s_cbranch_scc1 CPF_X
    s_getpc_b64 s[48:49]
    s_and_b32 s48, s48, 0xffffff00
    s_mov_b32 s50, 29952
    s_mov_b32 s51, 0x00020000
    s_lshl_b32 s97, s97, 13
    v_lshlrev_b32 v6, 7, v1
    buffer_load_dword v242, v6, s[48:51], s97 offen
CPF_X:
    s_cmp_lg_u32 s3, 2
    s_cbranch_scc1 TPF_X
    s_load_dwordx2 s[46:47], s[0:1], 56
    s_mov_b32 s48, s6
    s_mov_b32 s49, s7
    s_mov_b32 s50, 27262976
    s_mov_b32 s51, 0x00020000
    v_lshlrev_b32 v6, 20, v1
    buffer_load_dword v243, v6, s[48:51], 0 offen
    s_waitcnt lgkmcnt(0)
    s_mov_b32 s48, s46
    s_mov_b32 s49, s47
    s_mov_b32 s50, 1835008
    s_mov_b32 s51, 0x00020000
    buffer_load_dword v243, v6, s[48:51], 0 offen
TPF_X:
    s_mov_b32 s52, s100
    s_mov_b32 s53, s101
    s_mov_b32 s54, 256
    s_mov_b32 s55, 0x00020000
    s_or_b32 s97, s2, s3
    s_cmp_lg_u32 s97, 0
    s_cbranch_scc1 TAG_X
    s_or_b32 s97, s98, 1
    v_mov_b32 v6, s97
    v_mov_b32 v7, 0
    buffer_store_dword v6, v7, s[52:55], 0 offen sc1
TAG_X:
    s_mov_b32 s16, s6
    s_mov_b32 s17, s7
    s_mov_b32 s18, 1966080
    s_mov_b32 s19, 0x00020000
    s_lshr_b32 s9, s2, 3
    s_and_b32 s9, s9, 3
    s_lshl_b32 s9, s9, 2
    s_add_u32 s9, s9, s3
    v_mov_b32 v8, 0x3f803f80
    v_mov_b32 v9, 0x3f803f80
    v_mov_b32 v10, 0x3f803f80
    v_mov_b32 v11, 0x3f803f80
    v_lshlrev_b32 v5, 4, v1
    s_xor_b32 s24, s3, 0
    s_mul_i32 s24, s24, 7168
    v_add_u32 v210, s24, v5
    s_xor_b32 s24, s3, 1
    s_mul_i32 s24, s24, 7168
    v_add_u32 v211, s24, v5
    s_xor_b32 s24, s3, 2
    s_mul_i32 s24, s24, 7168
    v_add_u32 v212, s24, v5
    s_xor_b32 s24, s3, 3
    s_mul_i32 s24, s24, 7168
    v_add_u32 v213, s24, v5
    s_lshr_b32 s24, s3, 1
    s_lshl_b32 s24, s24, 8
    s_and_b32 s25, s3, 1
    s_lshl_b32 s25, s25, 3
    s_add_u32 s24, s24, s25
    v_lshl_add_u32 v214, v2, 4, s24
    s_lshr_b32 s24, s3, 1
    s_lshl_b32 s24, s24, 8
    v_lshl_add_u32 v215, v2, 4, s24
    s_xor_b32 s24, s24, 256
    v_lshl_add_u32 v216, v2, 4, s24
    s_lshl_b32 s24, s3, 8
    v_lshl_add_u32 v217, v2, 2, s24
    v_lshl_add_u32 v218, v3, 4, s24
    s_add_u32 s28, s6, 15204352
    s_addc_u32 s29, s7, 0
    s_mov_b32 s30, 8192
    s_mov_b32 s31, 0x00020000
    s_lshl_b32 s26, s8, 1
    s_lshr_b32 s27, s3, 1
    s_add_u32 s26, s26, s27
    s_lshl_b32 s26, s26, 6
    v_lshlrev_b32 v219, 2, v2
    s_cmp_ge_u32 s9, 15
    s_cbranch_scc1 P1_PF
    s_lshl_b32 s22, s9, 4
    v_add_u32 v192, s22, v2
    v_and_b32 v12, 1, v192
    v_cvt_f32_u32 v192, v192
    v_cvt_f32_u32 v12, v12
    v_fma_f32 v12, v12, -2.0, 1.0
    v_mov_b32 v13, v12
    v_mul_f32 v193, 0x3b124925, v192
    v_lshlrev_b32 v194, 3, v3
    v_cvt_f32_u32 v194, v194
    v_mul_f32 v194, v194, v193
    v_mul_f32 v14, 0x3d924925, v192
    v_cos_f32 v14, v14
    s_nop 0
    v_add_f32 v14, v14, v14
    v_mov_b32 v15, v14
    v_fmamk_f32 v196, v193, 0x00000000, v194
    v_cos_f32 v128, v196
    v_sin_f32 v136, -v196
    v_fmamk_f32 v197, v193, 0x3f800000, v194
    v_cos_f32 v129, v197
    v_sin_f32 v137, -v197
    v_fmamk_f32 v198, v193, 0x40000000, v194
    v_cos_f32 v130, v198
    v_sin_f32 v138, -v198
    v_fmamk_f32 v199, v193, 0x40400000, v194
    v_cos_f32 v131, v199
    v_sin_f32 v139, -v199
    v_fmamk_f32 v196, v193, 0x40800000, v194
    v_cos_f32 v132, v196
    v_sin_f32 v140, -v196
    v_fmamk_f32 v197, v193, 0x40a00000, v194
    v_cos_f32 v133, v197
    v_sin_f32 v141, -v197
    v_fmamk_f32 v198, v193, 0x40c00000, v194
    v_cos_f32 v134, v198
    v_sin_f32 v142, -v198
    v_fmamk_f32 v199, v193, 0x40e00000, v194
    v_cos_f32 v135, v199
    v_sin_f32 v143, -v199
    v_fmamk_f32 v196, v193, 0x42000000, v194
    v_cos_f32 v144, v196
    v_sin_f32 v152, -v196
    v_fmamk_f32 v197, v193, 0x42040000, v194
    v_cos_f32 v145, v197
    v_sin_f32 v153, -v197
    v_fmamk_f32 v198, v193, 0x42080000, v194
    v_cos_f32 v146, v198
    v_sin_f32 v154, -v198
    v_fmamk_f32 v199, v193, 0x420c0000, v194
    v_cos_f32 v147, v199
    v_sin_f32 v155, -v199
    v_fmamk_f32 v196, v193, 0x42100000, v194
    v_cos_f32 v148, v196
    v_sin_f32 v156, -v196
    v_fmamk_f32 v197, v193, 0x42140000, v194
    v_cos_f32 v149, v197
    v_sin_f32 v157, -v197
    v_fmamk_f32 v198, v193, 0x42180000, v194
    v_cos_f32 v150, v198
    v_sin_f32 v158, -v198
    v_fmamk_f32 v199, v193, 0x421c0000, v194
    v_cos_f32 v151, v199
    v_sin_f32 v159, -v199
    v_cvt_pk_bf16_f32 v72, v128, v129
    v_cvt_pk_bf16_f32 v73, v130, v131
    v_cvt_pk_bf16_f32 v74, v132, v133
    v_cvt_pk_bf16_f32 v75, v134, v135
    v_cvt_pk_bf16_f32 v100, v136, v137
    v_cvt_pk_bf16_f32 v101, v138, v139
    v_cvt_pk_bf16_f32 v102, v140, v141
    v_cvt_pk_bf16_f32 v103, v142, v143
    v_cvt_pk_bf16_f32 v76, v144, v145
    v_cvt_pk_bf16_f32 v77, v146, v147
    v_cvt_pk_bf16_f32 v78, v148, v149
    v_cvt_pk_bf16_f32 v79, v150, v151
    v_cvt_pk_bf16_f32 v104, v152, v153
    v_cvt_pk_bf16_f32 v105, v154, v155
    v_cvt_pk_bf16_f32 v106, v156, v157
    v_cvt_pk_bf16_f32 v107, v158, v159
    v_pk_fma_f32 v[128:129], v[14:15], v[144:145], v[128:129] neg_lo:[0,0,1] neg_hi:[0,0,1]
    v_pk_fma_f32 v[130:131], v[14:15], v[146:147], v[130:131] neg_lo:[0,0,1] neg_hi:[0,0,1]
    v_pk_fma_f32 v[132:133], v[14:15], v[148:149], v[132:133] neg_lo:[0,0,1] neg_hi:[0,0,1]
    v_pk_fma_f32 v[134:135], v[14:15], v[150:151], v[134:135] neg_lo:[0,0,1] neg_hi:[0,0,1]
    v_pk_fma_f32 v[136:137], v[14:15], v[152:153], v[136:137] neg_lo:[0,0,1] neg_hi:[0,0,1]
    v_pk_fma_f32 v[138:139], v[14:15], v[154:155], v[138:139] neg_lo:[0,0,1] neg_hi:[0,0,1]
    v_pk_fma_f32 v[140:141], v[14:15], v[156:157], v[140:141] neg_lo:[0,0,1] neg_hi:[0,0,1]
    v_pk_fma_f32 v[142:143], v[14:15], v[158:159], v[142:143] neg_lo:[0,0,1] neg_hi:[0,0,1]
    v_cvt_pk_bf16_f32 v80, v128, v129
    v_cvt_pk_bf16_f32 v81, v130, v131
    v_cvt_pk_bf16_f32 v82, v132, v133
    v_cvt_pk_bf16_f32 v83, v134, v135
    v_cvt_pk_bf16_f32 v108, v136, v137
    v_cvt_pk_bf16_f32 v109, v138, v139
    v_cvt_pk_bf16_f32 v110, v140, v141
    v_cvt_pk_bf16_f32 v111, v142, v143
    v_pk_fma_f32 v[144:145], v[14:15], v[128:129], v[144:145] neg_lo:[0,0,1] neg_hi:[0,0,1]
    v_pk_fma_f32 v[146:147], v[14:15], v[130:131], v[146:147] neg_lo:[0,0,1] neg_hi:[0,0,1]
    v_pk_fma_f32 v[148:149], v[14:15], v[132:133], v[148:149] neg_lo:[0,0,1] neg_hi:[0,0,1]
    v_pk_fma_f32 v[150:151], v[14:15], v[134:135], v[150:151] neg_lo:[0,0,1] neg_hi:[0,0,1]
    v_pk_fma_f32 v[152:153], v[14:15], v[136:137], v[152:153] neg_lo:[0,0,1] neg_hi:[0,0,1]
    v_pk_fma_f32 v[154:155], v[14:15], v[138:139], v[154:155] neg_lo:[0,0,1] neg_hi:[0,0,1]
    v_pk_fma_f32 v[156:157], v[14:15], v[140:141], v[156:157] neg_lo:[0,0,1] neg_hi:[0,0,1]
    v_pk_fma_f32 v[158:159], v[14:15], v[142:143], v[158:159] neg_lo:[0,0,1] neg_hi:[0,0,1]
    v_cvt_pk_bf16_f32 v84, v144, v145
    v_cvt_pk_bf16_f32 v85, v146, v147
    v_cvt_pk_bf16_f32 v86, v148, v149
    v_cvt_pk_bf16_f32 v87, v150, v151
    v_cvt_pk_bf16_f32 v112, v152, v153
    v_cvt_pk_bf16_f32 v113, v154, v155
    v_cvt_pk_bf16_f32 v114, v156, v157
    v_cvt_pk_bf16_f32 v115, v158, v159
    v_pk_fma_f32 v[128:129], v[14:15], v[144:145], v[128:129] neg_lo:[0,0,1] neg_hi:[0,0,1]
    v_pk_fma_f32 v[130:131], v[14:15], v[146:147], v[130:131] neg_lo:[0,0,1] neg_hi:[0,0,1]
    v_pk_fma_f32 v[132:133], v[14:15], v[148:149], v[132:133] neg_lo:[0,0,1] neg_hi:[0,0,1]
    v_pk_fma_f32 v[134:135], v[14:15], v[150:151], v[134:135] neg_lo:[0,0,1] neg_hi:[0,0,1]
    v_pk_fma_f32 v[136:137], v[14:15], v[152:153], v[136:137] neg_lo:[0,0,1] neg_hi:[0,0,1]
    v_pk_fma_f32 v[138:139], v[14:15], v[154:155], v[138:139] neg_lo:[0,0,1] neg_hi:[0,0,1]
    v_pk_fma_f32 v[140:141], v[14:15], v[156:157], v[140:141] neg_lo:[0,0,1] neg_hi:[0,0,1]
    v_pk_fma_f32 v[142:143], v[14:15], v[158:159], v[142:143] neg_lo:[0,0,1] neg_hi:[0,0,1]
    v_cvt_pk_bf16_f32 v88, v128, v129
    v_cvt_pk_bf16_f32 v89, v130, v131
    v_cvt_pk_bf16_f32 v90, v132, v133
    v_cvt_pk_bf16_f32 v91, v134, v135
    v_cvt_pk_bf16_f32 v116, v136, v137
    v_cvt_pk_bf16_f32 v117, v138, v139
    v_cvt_pk_bf16_f32 v118, v140, v141
    v_cvt_pk_bf16_f32 v119, v142, v143
    v_pk_fma_f32 v[144:145], v[14:15], v[128:129], v[144:145] neg_lo:[0,0,1] neg_hi:[0,0,1]
    v_pk_fma_f32 v[146:147], v[14:15], v[130:131], v[146:147] neg_lo:[0,0,1] neg_hi:[0,0,1]
    v_pk_fma_f32 v[148:149], v[14:15], v[132:133], v[148:149] neg_lo:[0,0,1] neg_hi:[0,0,1]
    v_pk_fma_f32 v[150:151], v[14:15], v[134:135], v[150:151] neg_lo:[0,0,1] neg_hi:[0,0,1]
    v_pk_fma_f32 v[152:153], v[14:15], v[136:137], v[152:153] neg_lo:[0,0,1] neg_hi:[0,0,1]
    v_pk_fma_f32 v[154:155], v[14:15], v[138:139], v[154:155] neg_lo:[0,0,1] neg_hi:[0,0,1]
    v_pk_fma_f32 v[156:157], v[14:15], v[140:141], v[156:157] neg_lo:[0,0,1] neg_hi:[0,0,1]
    v_pk_fma_f32 v[158:159], v[14:15], v[142:143], v[158:159] neg_lo:[0,0,1] neg_hi:[0,0,1]
    v_cvt_pk_bf16_f32 v92, v144, v145
    v_cvt_pk_bf16_f32 v93, v146, v147
    v_cvt_pk_bf16_f32 v94, v148, v149
    v_cvt_pk_bf16_f32 v95, v150, v151
    v_cvt_pk_bf16_f32 v120, v152, v153
    v_cvt_pk_bf16_f32 v121, v154, v155
    v_cvt_pk_bf16_f32 v122, v156, v157
    v_cvt_pk_bf16_f32 v123, v158, v159
    v_pk_fma_f32 v[128:129], v[14:15], v[144:145], v[128:129] neg_lo:[0,0,1] neg_hi:[0,0,1]
    v_pk_fma_f32 v[130:131], v[14:15], v[146:147], v[130:131] neg_lo:[0,0,1] neg_hi:[0,0,1]
    v_pk_fma_f32 v[132:133], v[14:15], v[148:149], v[132:133] neg_lo:[0,0,1] neg_hi:[0,0,1]
    v_pk_fma_f32 v[134:135], v[14:15], v[150:151], v[134:135] neg_lo:[0,0,1] neg_hi:[0,0,1]
    v_pk_fma_f32 v[136:137], v[14:15], v[152:153], v[136:137] neg_lo:[0,0,1] neg_hi:[0,0,1]
    v_pk_fma_f32 v[138:139], v[14:15], v[154:155], v[138:139] neg_lo:[0,0,1] neg_hi:[0,0,1]
    v_pk_fma_f32 v[140:141], v[14:15], v[156:157], v[140:141] neg_lo:[0,0,1] neg_hi:[0,0,1]
    v_pk_fma_f32 v[142:143], v[14:15], v[158:159], v[142:143] neg_lo:[0,0,1] neg_hi:[0,0,1]
    v_cvt_pk_bf16_f32 v96, v128, v129
    v_cvt_pk_bf16_f32 v97, v130, v131
    v_cvt_pk_bf16_f32 v98, v132, v133
    v_cvt_pk_bf16_f32 v99, v134, v135
    v_cvt_pk_bf16_f32 v124, v136, v137
    v_cvt_pk_bf16_f32 v125, v138, v139
    v_cvt_pk_bf16_f32 v126, v140, v141
    v_cvt_pk_bf16_f32 v127, v142, v143
    v_cvt_f32_u32 v200, v2
    v_mul_f32 v200, 0x3a000000, v200
    v_add_f32 v201, 0x3c000000, v200
    s_lshr_b32 s23, s3, 1
    s_lshl_b32 s23, s23, 10
    s_add_u32 s23, s23, s8
    v_lshlrev_b32 v202, 8, v3
    v_add_u32 v202, s23, v202
    v_cvt_f32_u32 v202, v202
    v_and_b32 v208, 1, v2
    v_mul_u32_u24 v208, 0x8000, v208
    v_lshl_or_b32 v208, v208, 16, v208
    v_mfma_f32_16x16x32_bf16 v[160:163], v[8:11], v[72:75], 0
    v_add_f32 v203, 0x00000000, v202
    v_mul_f32 v196, v200, v203
    v_mul_f32 v197, v201, v203
    v_cos_f32 v204, v196
    v_mfma_f32_16x16x32_bf16 v[164:167], v[8:11], v[100:103], 0
    v_sin_f32 v205, v196
    v_cos_f32 v206, v197
    v_sin_f32 v207, v197
    v_cvt_pk_bf16_f32 v168, v204, v205
    v_mfma_f32_16x16x32_bf16 v[160:163], v[8:11], v[76:79], v[160:163]
    v_cvt_pk_bf16_f32 v176, v206, v207
    v_xor_b32 v172, v208, v168
    v_xor_b32 v180, v208, v176
    v_add_f32 v203, 0x42800000, v202
    v_mfma_f32_16x16x32_bf16 v[164:167], v[8:11], v[104:107], v[164:167]
    v_mul_f32 v196, v200, v203
    v_mul_f32 v197, v201, v203
    v_cos_f32 v204, v196
    v_sin_f32 v205, v196
    v_mfma_f32_16x16x32_bf16 v[160:163], v[8:11], v[80:83], v[160:163]
    v_cos_f32 v206, v197
    v_sin_f32 v207, v197
    v_cvt_pk_bf16_f32 v169, v204, v205
    v_cvt_pk_bf16_f32 v177, v206, v207
    v_mfma_f32_16x16x32_bf16 v[164:167], v[8:11], v[108:111], v[164:167]
    v_xor_b32 v173, v208, v169
    v_xor_b32 v181, v208, v177
    v_add_f32 v203, 0x43000000, v202
    v_mul_f32 v196, v200, v203
    v_mfma_f32_16x16x32_bf16 v[160:163], v[8:11], v[84:87], v[160:163]
    v_mul_f32 v197, v201, v203
    v_cos_f32 v204, v196
    v_sin_f32 v205, v196
    v_cos_f32 v206, v197
    v_mfma_f32_16x16x32_bf16 v[164:167], v[8:11], v[112:115], v[164:167]
    v_sin_f32 v207, v197
    v_cvt_pk_bf16_f32 v170, v204, v205
    v_cvt_pk_bf16_f32 v178, v206, v207
    v_xor_b32 v174, v208, v170
    v_mfma_f32_16x16x32_bf16 v[160:163], v[8:11], v[88:91], v[160:163]
    v_xor_b32 v182, v208, v178
    v_add_f32 v203, 0x43400000, v202
    v_mul_f32 v196, v200, v203
    v_mul_f32 v197, v201, v203
    v_mfma_f32_16x16x32_bf16 v[164:167], v[8:11], v[116:119], v[164:167]
    v_cos_f32 v204, v196
    v_sin_f32 v205, v196
    v_cos_f32 v206, v197
    v_sin_f32 v207, v197
    v_mfma_f32_16x16x32_bf16 v[160:163], v[8:11], v[92:95], v[160:163]
    v_cvt_pk_bf16_f32 v171, v204, v205
    v_cvt_pk_bf16_f32 v179, v206, v207
    v_xor_b32 v175, v208, v171
    v_xor_b32 v183, v208, v179
    v_mfma_f32_16x16x32_bf16 v[164:167], v[8:11], v[120:123], v[164:167]
    s_and_b32 s24, s3, 1
    s_cmp_eq_u32 s24, 1
    s_cselect_b64 vcc, -1, 0
    v_cndmask_b32 v220, 1.0, v12, vcc
    v_mov_b32 v221, v220
    v_mfma_f32_16x16x32_bf16 v[160:163], v[8:11], v[96:99], v[160:163]
    v_mfma_f32_16x16x32_bf16 v[164:167], v[8:11], v[124:127], v[164:167]
    s_nop 6
    v_fma_f32 v200, v160, v12, v160
    v_mov_b32 v201, v200
    v_fma_f32 v202, v164, v12, v164
    v_mov_b32 v203, v202
    s_mov_b32 s52, s100
    s_mov_b32 s53, s101
    s_mov_b32 s54, 256
    s_mov_b32 s55, 0x00020000
    v_mov_b32 v241, 0
    buffer_load_dword v240, v241, s[52:55], 0 offen sc1
    s_waitcnt vmcnt(1)
    s_branch P1_XOK
P1_PF:
    s_lshr_b32 s46, s2, 5
    v_and_b32 v6, 3, v1
    v_lshlrev_b32 v6, 7, v6
    v_lshrrev_b32 v222, 2, v1
    s_mov_b32 s48, s56
    s_mov_b32 s49, s57
    s_mov_b32 s50, 921600
    s_mov_b32 s51, 0x00020000
    s_mov_b32 s52, s58
    s_mov_b32 s53, s59
    s_mov_b32 s54, 921600
    s_mov_b32 s55, 0x00020000
    s_lshl_b32 s47, s46, 5
    s_add_u32 s47, s47, 0
    v_add_u32 v223, s47, v222
    v_and_b32 v224, 3, v223
    v_lshrrev_b32 v223, 2, v223
    v_lshl_add_u32 v223, v223, 5, v224
    s_and_b32 s47, s2, 7
    s_lshl_b32 s47, s47, 2
    v_add_u32 v223, s47, v223
    v_mul_u32_u24 v223, 450, v223
    v_and_b32 v223, 0xffffff80, v223
    v_add_u32 v223, v6, v223
    buffer_load_dword v209, v223, s[48:51], 0 offen
    buffer_load_dword v209, v223, s[52:55], 0 offen
    v_add_u32 v223, 450, v223
    v_and_b32 v223, 0xffffff80, v223
    buffer_load_dword v209, v223, s[48:51], 0 offen offset:0
    buffer_load_dword v209, v223, s[52:55], 0 offen offset:0
    s_lshl_b32 s47, s46, 5
    s_add_u32 s47, s47, 16
    v_add_u32 v223, s47, v222
    v_and_b32 v224, 3, v223
    v_lshrrev_b32 v223, 2, v223
    v_lshl_add_u32 v223, v223, 5, v224
    s_and_b32 s47, s2, 7
    s_lshl_b32 s47, s47, 2
    v_add_u32 v223, s47, v223
    v_mul_u32_u24 v223, 450, v223
    v_and_b32 v223, 0xffffff80, v223
    v_add_u32 v223, v6, v223
    buffer_load_dword v209, v223, s[48:51], 0 offen
    buffer_load_dword v209, v223, s[52:55], 0 offen
    v_add_u32 v223, 450, v223
    v_and_b32 v223, 0xffffff80, v223
    buffer_load_dword v209, v223, s[48:51], 0 offen offset:0
    buffer_load_dword v209, v223, s[52:55], 0 offen offset:0
    s_mov_b32 s52, s100
    s_mov_b32 s53, s101
    s_mov_b32 s54, 256
    s_mov_b32 s55, 0x00020000
    v_mov_b32 v241, 0
    buffer_load_dword v240, v241, s[52:55], 0 offen sc1
    s_waitcnt vmcnt(9)
P1_XOK:
    s_barrier
    ds_read_b128 v[16:19], v210 offset:0
    ds_read_b128 v[20:23], v210 offset:1024
    ds_read_b128 v[24:27], v210 offset:2048
    ds_read_b128 v[28:31], v210 offset:3072
    ds_read_b128 v[32:35], v210 offset:4096
    ds_read_b128 v[36:39], v210 offset:5120
    ds_read_b128 v[40:43], v210 offset:6144
    ds_read_b128 v[44:47], v211 offset:0
    ds_read_b128 v[48:51], v211 offset:1024
    ds_read_b128 v[52:55], v211 offset:2048
    ds_read_b128 v[56:59], v211 offset:3072
    ds_read_b128 v[60:63], v211 offset:4096
    ds_read_b128 v[64:67], v211 offset:5120
    ds_read_b128 v[68:71], v211 offset:6144
    s_waitcnt lgkmcnt(13)
    v_mfma_f32_16x16x32_bf16 v[128:131], v[16:19], v[72:75], 0
    v_dot2_f32_bf16 v184, v16, v8, 0
    v_dot2_f32_bf16 v185, v16, v16, 0
    v_dot2_f32_bf16 v186, v17, v8, 0
    v_dot2_f32_bf16 v187, v17, v17, 0
    v_mfma_f32_16x16x32_bf16 v[132:135], v[16:19], v[100:103], 0
    v_dot2_f32_bf16 v184, v18, v8, v184
    v_dot2_f32_bf16 v185, v18, v18, v185
    v_dot2_f32_bf16 v186, v19, v8, v186
    v_dot2_f32_bf16 v187, v19, v19, v187
    s_waitcnt lgkmcnt(12)
    v_mfma_f32_16x16x32_bf16 v[128:131], v[20:23], v[76:79], v[128:131]
    v_dot2_f32_bf16 v184, v20, v8, v184
    v_dot2_f32_bf16 v185, v20, v20, v185
    v_dot2_f32_bf16 v186, v21, v8, v186
    v_dot2_f32_bf16 v187, v21, v21, v187
    v_mfma_f32_16x16x32_bf16 v[132:135], v[20:23], v[104:107], v[132:135]
    v_dot2_f32_bf16 v184, v22, v8, v184
    v_dot2_f32_bf16 v185, v22, v22, v185
    v_dot2_f32_bf16 v186, v23, v8, v186
    v_dot2_f32_bf16 v187, v23, v23, v187
    s_waitcnt lgkmcnt(11)
    v_mfma_f32_16x16x32_bf16 v[128:131], v[24:27], v[80:83], v[128:131]
    v_dot2_f32_bf16 v184, v24, v8, v184
    v_dot2_f32_bf16 v185, v24, v24, v185
    v_dot2_f32_bf16 v186, v25, v8, v186
    v_dot2_f32_bf16 v187, v25, v25, v187
    v_mfma_f32_16x16x32_bf16 v[132:135], v[24:27], v[108:111], v[132:135]
    v_dot2_f32_bf16 v184, v26, v8, v184
    v_dot2_f32_bf16 v185, v26, v26, v185
    v_dot2_f32_bf16 v186, v27, v8, v186
    v_dot2_f32_bf16 v187, v27, v27, v187
    s_waitcnt lgkmcnt(10)
    v_mfma_f32_16x16x32_bf16 v[128:131], v[28:31], v[84:87], v[128:131]
    v_dot2_f32_bf16 v184, v28, v8, v184
    v_dot2_f32_bf16 v185, v28, v28, v185
    v_dot2_f32_bf16 v186, v29, v8, v186
    v_dot2_f32_bf16 v187, v29, v29, v187
    v_mfma_f32_16x16x32_bf16 v[132:135], v[28:31], v[112:115], v[132:135]
    v_dot2_f32_bf16 v184, v30, v8, v184
    v_dot2_f32_bf16 v185, v30, v30, v185
    v_dot2_f32_bf16 v186, v31, v8, v186
    v_dot2_f32_bf16 v187, v31, v31, v187
    s_waitcnt lgkmcnt(9)
    v_mfma_f32_16x16x32_bf16 v[128:131], v[32:35], v[88:91], v[128:131]
    v_dot2_f32_bf16 v184, v32, v8, v184
    v_dot2_f32_bf16 v185, v32, v32, v185
    v_dot2_f32_bf16 v186, v33, v8, v186
    v_dot2_f32_bf16 v187, v33, v33, v187
    v_mfma_f32_16x16x32_bf16 v[132:135], v[32:35], v[116:119], v[132:135]
    v_dot2_f32_bf16 v184, v34, v8, v184
    v_dot2_f32_bf16 v185, v34, v34, v185
    v_dot2_f32_bf16 v186, v35, v8, v186
    v_dot2_f32_bf16 v187, v35, v35, v187
    s_waitcnt lgkmcnt(8)
    v_mfma_f32_16x16x32_bf16 v[128:131], v[36:39], v[92:95], v[128:131]
    v_dot2_f32_bf16 v184, v36, v8, v184
    v_dot2_f32_bf16 v185, v36, v36, v185
    v_dot2_f32_bf16 v186, v37, v8, v186
    v_dot2_f32_bf16 v187, v37, v37, v187
    v_mfma_f32_16x16x32_bf16 v[132:135], v[36:39], v[120:123], v[132:135]
    v_dot2_f32_bf16 v184, v38, v8, v184
    v_dot2_f32_bf16 v185, v38, v38, v185
    v_dot2_f32_bf16 v186, v39, v8, v186
    v_dot2_f32_bf16 v187, v39, v39, v187
    s_waitcnt lgkmcnt(7)
    v_mfma_f32_16x16x32_bf16 v[128:131], v[40:43], v[96:99], v[128:131]
    v_dot2_f32_bf16 v184, v40, v8, v184
    v_dot2_f32_bf16 v185, v40, v40, v185
    v_dot2_f32_bf16 v186, v41, v8, v186
    v_dot2_f32_bf16 v187, v41, v41, v187
    v_mfma_f32_16x16x32_bf16 v[132:135], v[40:43], v[124:127], v[132:135]
    v_dot2_f32_bf16 v184, v42, v8, v184
    v_dot2_f32_bf16 v185, v42, v42, v185
    v_dot2_f32_bf16 v186, v43, v8, v186
    v_dot2_f32_bf16 v187, v43, v43, v187
    s_waitcnt lgkmcnt(0)
    v_mfma_f32_16x16x32_bf16 v[136:139], v[44:47], v[72:75], 0
    s_nop 0
    v_pk_add_f32 v[184:185], v[184:185], v[186:187]
    v_mov_b32 v188, v184
    v_mfma_f32_16x16x32_bf16 v[140:143], v[44:47], v[100:103], 0
    v_mov_b32 v189, v185
    v_permlane16_swap_b32 v184, v188
    v_mfma_f32_16x16x32_bf16 v[136:139], v[48:51], v[76:79], v[136:139]
    v_permlane16_swap_b32 v185, v189
    v_add_f32 v184, v184, v188
    v_mfma_f32_16x16x32_bf16 v[140:143], v[48:51], v[104:107], v[140:143]
    v_add_f32 v185, v185, v189
    v_mov_b32 v188, v184
    v_mfma_f32_16x16x32_bf16 v[136:139], v[52:55], v[80:83], v[136:139]
    v_mov_b32 v189, v185
    v_permlane32_swap_b32 v184, v188
    v_mfma_f32_16x16x32_bf16 v[140:143], v[52:55], v[108:111], v[140:143]
    v_permlane32_swap_b32 v185, v189
    v_add_f32 v184, v184, v188
    v_mfma_f32_16x16x32_bf16 v[136:139], v[56:59], v[84:87], v[136:139]
    v_add_f32 v185, v185, v189
    ds_write_b64 v214, v[184:185] offset:28672
    v_mfma_f32_16x16x32_bf16 v[140:143], v[56:59], v[112:115], v[140:143]
    s_waitcnt lgkmcnt(0)
    s_barrier
    s_cmp_ge_u32 s9, 15
    s_cbranch_scc1 P1_PUB2
    ds_read_b128 v[184:187], v215 offset:28672
    ds_read_b128 v[188:191], v216 offset:28672
    ds_read_b128 v[16:19], v212 offset:0
    ds_read_b128 v[20:23], v212 offset:1024
    ds_read_b128 v[24:27], v212 offset:2048
    ds_read_b128 v[28:31], v212 offset:3072
    ds_read_b128 v[32:35], v212 offset:4096
    ds_read_b128 v[36:39], v212 offset:5120
    ds_read_b128 v[40:43], v212 offset:6144
    v_mfma_f32_16x16x32_bf16 v[136:139], v[60:63], v[88:91], v[136:139]
    v_mfma_f32_16x16x32_bf16 v[140:143], v[60:63], v[116:119], v[140:143]
    v_mfma_f32_16x16x32_bf16 v[136:139], v[64:67], v[92:95], v[136:139]
    v_mfma_f32_16x16x32_bf16 v[140:143], v[64:67], v[120:123], v[140:143]
    v_mfma_f32_16x16x32_bf16 v[136:139], v[68:71], v[96:99], v[136:139]
    v_mfma_f32_16x16x32_bf16 v[140:143], v[68:71], v[124:127], v[140:143]
    ds_read_b128 v[44:47], v213 offset:0
    ds_read_b128 v[48:51], v213 offset:1024
    ds_read_b128 v[52:55], v213 offset:2048
    ds_read_b128 v[56:59], v213 offset:3072
    ds_read_b128 v[60:63], v213 offset:4096
    ds_read_b128 v[64:67], v213 offset:5120
    ds_read_b128 v[68:71], v213 offset:6144
    s_waitcnt lgkmcnt(14)
    s_waitcnt lgkmcnt(13)
    v_mfma_f32_16x16x32_bf16 v[144:147], v[16:19], v[72:75], 0
    v_pk_add_f32 v[184:185], v[184:185], v[186:187]
    v_pk_add_f32 v[186:187], v[188:189], v[190:191]
    buffer_store_dword v184, v219, s[28:31], s26 offen sc1
    v_mfma_f32_16x16x32_bf16 v[148:151], v[16:19], v[100:103], 0
    v_mul_f32 v184, 0x3b124925, v184
    v_mul_f32 v186, 0x3b124925, v186
    v_mul_f32 v185, 0x3b124925, v185
    s_waitcnt lgkmcnt(12)
    v_mfma_f32_16x16x32_bf16 v[144:147], v[20:23], v[76:79], v[144:147]
    v_mul_f32 v187, 0x3b124925, v187
    v_fma_f32 v185, -v184, v184, v185
    v_fma_f32 v187, -v186, v186, v187
    v_mfma_f32_16x16x32_bf16 v[148:151], v[20:23], v[104:107], v[148:151]
    v_max_f32 v185, 0, v185
    v_max_f32 v187, 0, v187
    v_cvt_pk_bf16_f32 v188, v184, v186
    s_waitcnt lgkmcnt(11)
    v_mfma_f32_16x16x32_bf16 v[144:147], v[24:27], v[80:83], v[144:147]
    v_lshlrev_b32 v184, 16, v188
    v_and_b32 v186, 0xffff0000, v188
    v_cvt_pk_bf16_f32 v188, v185, v187
    v_mfma_f32_16x16x32_bf16 v[148:151], v[24:27], v[108:111], v[148:151]
    v_lshlrev_b32 v185, 16, v188
    v_and_b32 v187, 0xffff0000, v188
    v_add_f32 v185, 0x3727c5ac, v185
    s_waitcnt lgkmcnt(10)
    v_mfma_f32_16x16x32_bf16 v[144:147], v[28:31], v[84:87], v[144:147]
    v_add_f32 v187, 0x3727c5ac, v187
    v_cvt_pk_bf16_f32 v188, v185, v187
    v_lshlrev_b32 v185, 16, v188
    v_mfma_f32_16x16x32_bf16 v[148:151], v[28:31], v[112:115], v[148:151]
    v_and_b32 v187, 0xffff0000, v188
    v_sqrt_f32 v185, v185
    v_sqrt_f32 v187, v187
    s_waitcnt lgkmcnt(9)
    v_mfma_f32_16x16x32_bf16 v[144:147], v[32:35], v[88:91], v[144:147]
    v_cvt_pk_bf16_f32 v188, v185, v187
    v_lshlrev_b32 v185, 16, v188
    v_and_b32 v187, 0xffff0000, v188
    v_mfma_f32_16x16x32_bf16 v[148:151], v[32:35], v[116:119], v[148:151]
    v_rcp_f32 v185, v185
    v_rcp_f32 v187, v187
    v_mul_f32 v184, v184, v185
    s_waitcnt lgkmcnt(8)
    v_mfma_f32_16x16x32_bf16 v[144:147], v[36:39], v[92:95], v[144:147]
    v_mul_f32 v186, v186, v187
    v_mfma_f32_16x16x32_bf16 v[148:151], v[36:39], v[120:123], v[148:151]
    s_waitcnt lgkmcnt(7)
    v_mfma_f32_16x16x32_bf16 v[144:147], v[40:43], v[96:99], v[144:147]
    v_mfma_f32_16x16x32_bf16 v[148:151], v[40:43], v[124:127], v[148:151]
    s_waitcnt lgkmcnt(0)
    ds_write_b32 v217, v185 offset:29184
    ds_write_b32 v217, v187 offset:29248
    ds_write_b32 v217, v184 offset:29312
    ds_write_b32 v217, v186 offset:29376
    v_mfma_f32_16x16x32_bf16 v[152:155], v[44:47], v[72:75], 0
    v_mfma_f32_16x16x32_bf16 v[156:159], v[44:47], v[100:103], 0
    v_mfma_f32_16x16x32_bf16 v[152:155], v[48:51], v[76:79], v[152:155]
    v_mfma_f32_16x16x32_bf16 v[156:159], v[48:51], v[104:107], v[156:159]
    s_waitcnt lgkmcnt(0)
    ds_read_b128 v[224:227], v218 offset:29184
    ds_read_b128 v[232:235], v218 offset:29312
    ds_read_b128 v[228:231], v218 offset:29248
    ds_read_b128 v[236:239], v218 offset:29376
    v_mfma_f32_16x16x32_bf16 v[152:155], v[52:55], v[80:83], v[152:155]
    v_mfma_f32_16x16x32_bf16 v[156:159], v[52:55], v[108:111], v[156:159]
    v_mfma_f32_16x16x32_bf16 v[152:155], v[56:59], v[84:87], v[152:155]
    v_mfma_f32_16x16x32_bf16 v[156:159], v[56:59], v[112:115], v[156:159]
    v_mfma_f32_16x16x32_bf16 v[152:155], v[60:63], v[88:91], v[152:155]
    v_mfma_f32_16x16x32_bf16 v[156:159], v[60:63], v[116:119], v[156:159]
    v_mfma_f32_16x16x32_bf16 v[152:155], v[64:67], v[92:95], v[152:155]
    v_mfma_f32_16x16x32_bf16 v[156:159], v[64:67], v[120:123], v[156:159]
    v_mfma_f32_16x16x32_bf16 v[152:155], v[68:71], v[96:99], v[152:155]
    v_mfma_f32_16x16x32_bf16 v[156:159], v[68:71], v[124:127], v[156:159]
    s_waitcnt lgkmcnt(0)
    v_pk_mul_f32 v[224:225], v[224:225], v[220:221]
    v_pk_mul_f32 v[226:227], v[226:227], v[220:221]
    v_pk_mul_f32 v[228:229], v[228:229], v[220:221]
    v_pk_mul_f32 v[230:231], v[230:231], v[220:221]
    v_pk_fma_f32 v[128:129], v[136:137], v[12:13], v[128:129]
    v_pk_mul_f32 v[136:137], v[232:233], v[200:201]
    v_pk_fma_f32 v[128:129], v[128:129], v[224:225], v[136:137] neg_lo:[0,0,1] neg_hi:[0,0,1]
    v_pk_fma_f32 v[130:131], v[138:139], v[12:13], v[130:131]
    v_pk_mul_f32 v[138:139], v[234:235], v[200:201]
    v_pk_fma_f32 v[130:131], v[130:131], v[226:227], v[138:139] neg_lo:[0,0,1] neg_hi:[0,0,1]
    v_pk_fma_f32 v[132:133], v[140:141], v[12:13], v[132:133]
    v_pk_mul_f32 v[140:141], v[232:233], v[202:203]
    v_pk_fma_f32 v[132:133], v[132:133], v[224:225], v[140:141] neg_lo:[0,0,1] neg_hi:[0,0,1]
    v_pk_fma_f32 v[134:135], v[142:143], v[12:13], v[134:135]
    v_pk_mul_f32 v[142:143], v[234:235], v[202:203]
    v_pk_fma_f32 v[134:135], v[134:135], v[226:227], v[142:143] neg_lo:[0,0,1] neg_hi:[0,0,1]
    v_cvt_pk_bf16_f32 v16, v128, v132
    v_cvt_pk_bf16_f32 v24, v132, -v128
    v_cvt_pk_bf16_f32 v17, v129, v133
    v_cvt_pk_bf16_f32 v25, v133, -v129
    v_cvt_pk_bf16_f32 v18, v130, v134
    v_cvt_pk_bf16_f32 v26, v134, -v130
    v_cvt_pk_bf16_f32 v19, v131, v135
    v_cvt_pk_bf16_f32 v27, v135, -v131
    s_nop 0
    v_mfma_f32_16x16x32_bf16 v[32:35], v[168:171], v[16:19], 0
    v_mfma_f32_16x16x32_bf16 v[40:43], v[168:171], v[24:27], 0
    v_mfma_f32_16x16x32_bf16 v[36:39], v[176:179], v[16:19], 0
    v_mfma_f32_16x16x32_bf16 v[44:47], v[176:179], v[24:27], 0
    v_pk_fma_f32 v[144:145], v[152:153], v[12:13], v[144:145]
    v_pk_mul_f32 v[152:153], v[236:237], v[200:201]
    v_pk_fma_f32 v[144:145], v[144:145], v[228:229], v[152:153] neg_lo:[0,0,1] neg_hi:[0,0,1]
    v_pk_fma_f32 v[146:147], v[154:155], v[12:13], v[146:147]
    v_pk_mul_f32 v[154:155], v[238:239], v[200:201]
    v_pk_fma_f32 v[146:147], v[146:147], v[230:231], v[154:155] neg_lo:[0,0,1] neg_hi:[0,0,1]
    v_pk_fma_f32 v[148:149], v[156:157], v[12:13], v[148:149]
    v_pk_mul_f32 v[156:157], v[236:237], v[202:203]
    v_pk_fma_f32 v[148:149], v[148:149], v[228:229], v[156:157] neg_lo:[0,0,1] neg_hi:[0,0,1]
    v_pk_fma_f32 v[150:151], v[158:159], v[12:13], v[150:151]
    v_pk_mul_f32 v[158:159], v[238:239], v[202:203]
    v_pk_fma_f32 v[150:151], v[150:151], v[230:231], v[158:159] neg_lo:[0,0,1] neg_hi:[0,0,1]
    v_cvt_pk_bf16_f32 v20, v144, v148
    v_cvt_pk_bf16_f32 v28, v148, -v144
    v_cvt_pk_bf16_f32 v21, v145, v149
    v_cvt_pk_bf16_f32 v29, v149, -v145
    v_cvt_pk_bf16_f32 v22, v146, v150
    v_cvt_pk_bf16_f32 v30, v150, -v146
    v_cvt_pk_bf16_f32 v23, v147, v151
    v_cvt_pk_bf16_f32 v31, v151, -v147
    s_nop 0
    v_mfma_f32_16x16x32_bf16 v[32:35], v[172:175], v[20:23], v[32:35]
    v_mfma_f32_16x16x32_bf16 v[40:43], v[172:175], v[28:31], v[40:43]
    v_mfma_f32_16x16x32_bf16 v[36:39], v[180:183], v[20:23], v[36:39]
    v_mfma_f32_16x16x32_bf16 v[44:47], v[180:183], v[28:31], v[44:47]
    s_lshl_b32 s24, s9, 6
    s_add_u32 s24, s24, s8
    s_lshl_b32 s24, s24, 11
    s_nop 2
    v_cvt_pk_bf16_f32 v48, v32, v40
    v_cvt_pk_bf16_f32 v49, v33, v41
    v_cvt_pk_bf16_f32 v50, v34, v42
    v_cvt_pk_bf16_f32 v51, v35, v43
    buffer_store_dwordx4 v[48:51], v5, s[16:19], s24 offen offset:0 sc1
    v_cvt_pk_bf16_f32 v52, v36, v44
    v_cvt_pk_bf16_f32 v53, v37, v45
    v_cvt_pk_bf16_f32 v54, v38, v46
    v_cvt_pk_bf16_f32 v55, v39, v47
    buffer_store_dwordx4 v[52:55], v5, s[16:19], s24 offen offset:1024 sc1
    s_nop 7
    s_nop 7
P1_PUB:
    s_waitcnt vmcnt(0)
    s_mov_b32 s63, 0
TAG_LOOP:
    v_readfirstlane_b32 s96, v240
    s_nop 3
    s_cmp_lg_u32 s96, 0
    s_cbranch_scc1 TAG_OK
    buffer_load_dword v240, v241, s[52:55], 0 offen sc1
    s_add_u32 s63, s63, 1
    s_waitcnt vmcnt(0)
    s_cmp_lt_u32 s63, 0x40000
    s_cbranch_scc1 TAG_LOOP
TAG_OK:
P1_PUB2:
    s_barrier
    s_cmp_lt_u32 s9, 15
    s_cbranch_scc1 TAG2_OK
    s_waitcnt vmcnt(0)
    s_mov_b32 s63, 0
TAG2_LOOP:
    v_readfirstlane_b32 s96, v240
    s_nop 3
    s_cmp_lg_u32 s96, 0
    s_cbranch_scc1 TAG2_OK
    buffer_load_dword v240, v241, s[52:55], 0 offen sc1
    s_add_u32 s63, s63, 1
    s_waitcnt vmcnt(0)
    s_cmp_lt_u32 s63, 0x40000
    s_cbranch_scc1 TAG2_LOOP
TAG2_OK:
    s_add_u32 s52, s6, 15466496
    s_addc_u32 s53, s7, 0
    s_mov_b32 s54, 40960
    s_mov_b32 s55, 0x00020000
    s_cmp_lg_u32 s3, 0
    s_cbranch_scc1 E1F_NF
    s_bfe_u32 s34, s2, 0x20003
    s_lshl_b32 s34, s34, 2
    s_lshr_b32 s35, s8, 4
    s_add_u32 s34, s34, s35
    s_lshl_b32 s34, s34, 7
    s_and_b32 s35, s8, 15
    s_lshl_b32 s35, s35, 2
    s_add_u32 s34, s34, s35
    s_add_u32 s34, s34, 4096
    v_mov_b32 v12, s96
    v_mov_b32 v13, 0
    buffer_store_dword v12, v13, s[52:55], s34 offen sc1
E1F_NF:
    s_sub_u32 s33, s2, 120
    s_cmp_lt_u32 s33, 98
    s_cbranch_scc1 EWE_NF
    s_cmp_lg_u32 s3, 0
    s_cbranch_scc1 EWE_NF
    s_and_b32 s34, s2, 15
    s_lshl_b32 s34, s34, 7
    s_lshr_b32 s35, s2, 4
    s_lshl_b32 s35, s35, 2
    s_add_u32 s34, s34, s35
    s_add_u32 s34, s34, 24576
    v_mov_b32 v12, s96
    v_lshlrev_b32 v13, 11, v1
    v_cmp_gt_u32 vcc, 8, v1
    v_mov_b32 v11, 0x7ff00000
    s_nop 0
    v_cndmask_b32 v13, v11, v13, vcc
    buffer_store_dword v12, v13, s[52:55], s34 offen sc1
EWE_NF:
    s_cmp_lt_u32 s2, 120
    s_cbranch_scc1 P2_MAIN
    s_cmp_lg_u32 s3, 0
    s_cbranch_scc1 E2E_NF
    s_and_b32 s34, s2, 15
    s_lshl_b32 s34, s34, 7
    s_lshr_b32 s35, s2, 4
    s_lshl_b32 s35, s35, 2
    s_add_u32 s34, s34, s35
    s_add_u32 s34, s34, 8192
    v_mov_b32 v12, s96
    v_lshlrev_b32 v13, 11, v1
    v_cmp_gt_u32 vcc, 8, v1
    v_mov_b32 v11, 0x7ff00000
    s_nop 0
    v_cndmask_b32 v13, v11, v13, vcc
    buffer_store_dword v12, v13, s[52:55], s34 offen sc1
E2E_NF:
    s_cmp_lt_u32 s2, 120
    s_cbranch_scc1 RL_LX
    s_cmp_ge_u32 s2, 246
    s_cbranch_scc1 RL_LX
    s_cmp_ge_u32 s2, 218
    s_cbranch_scc1 RL_LD
    v_lshlrev_b32 v6, 3, v1
    s_sub_u32 s11, s2, 120
    s_lshl_b32 s11, s11, 2
    s_add_u32 s11, s11, s3
    s_mul_hi_u32 s24, s11, 613566757
    s_mul_i32 s25, s24, 7
    s_sub_u32 s25, s11, s25
    s_and_b32 s26, s24, 3
    s_lshr_b32 s27, s24, 2
    s_cmp_ge_u32 s27, 14
    s_cselect_b32 s28, 1, 0
    s_mul_i32 s29, s28, 14
    s_sub_u32 s27, s27, s29
    s_lshl_b32 s29, s27, 2
    s_add_u32 s29, s29, s26
    s_mul_i32 s29, s29, 28672
    s_lshl_b32 s32, s25, 9
    s_add_u32 s34, s29, s32
    s_mul_i32 s29, s25, 458752
    s_lshl_b32 s32, s27, 12
    s_add_u32 s29, s29, s32
    s_lshl_b32 s32, s28, 10
    s_add_u32 s29, s29, s32
    s_lshr_b32 s32, s26, 1
    s_lshl_b32 s32, s32, 11
    s_add_u32 s29, s29, s32
    s_and_b32 s32, s26, 1
    s_lshl_b32 s32, s32, 9
    s_add_u32 s35, s29, s32
    s_cmp_eq_u32 s28, 0
    s_cselect_b32 s48, s40, s42
    s_cselect_b32 s49, s41, s43
    s_mov_b32 s50, 1605632
    s_mov_b32 s51, 0x00020000
    buffer_load_dwordx2 a[0:1], v6, s[48:51], s34 offen
    s_add_u32 s34, s34, 3584
    buffer_load_dwordx2 a[2:3], v6, s[48:51], s34 offen
    s_add_u32 s34, s34, 3584
    buffer_load_dwordx2 a[4:5], v6, s[48:51], s34 offen
    s_add_u32 s34, s34, 3584
    buffer_load_dwordx2 a[6:7], v6, s[48:51], s34 offen
    s_add_u32 s34, s34, 3584
    buffer_load_dwordx2 a[8:9], v6, s[48:51], s34 offen
    s_add_u32 s34, s34, 3584
    buffer_load_dwordx2 a[10:11], v6, s[48:51], s34 offen
    s_add_u32 s34, s34, 3584
    buffer_load_dwordx2 a[12:13], v6, s[48:51], s34 offen
    s_add_u32 s34, s34, 3584
    buffer_load_dwordx2 a[14:15], v6, s[48:51], s34 offen
    s_sub_u32 s11, s2, 120
    s_lshl_b32 s11, s11, 2
    s_add_u32 s11, s11, s3
    s_add_u32 s11, s11, 392
    s_mul_hi_u32 s24, s11, 613566757
    s_mul_i32 s25, s24, 7
    s_sub_u32 s25, s11, s25
    s_and_b32 s26, s24, 3
    s_lshr_b32 s27, s24, 2
    s_cmp_ge_u32 s27, 14
    s_cselect_b32 s28, 1, 0
    s_mul_i32 s29, s28, 14
    s_sub_u32 s27, s27, s29
    s_lshl_b32 s29, s27, 2
    s_add_u32 s29, s29, s26
    s_mul_i32 s29, s29, 28672
    s_lshl_b32 s32, s25, 9
    s_add_u32 s34, s29, s32
    s_mul_i32 s29, s25, 458752
    s_lshl_b32 s32, s27, 12
    s_add_u32 s29, s29, s32
    s_lshl_b32 s32, s28, 10
    s_add_u32 s29, s29, s32
    s_lshr_b32 s32, s26, 1
    s_lshl_b32 s32, s32, 11
    s_add_u32 s29, s29, s32
    s_and_b32 s32, s26, 1
    s_lshl_b32 s32, s32, 9
    s_add_u32 s35, s29, s32
    s_cmp_eq_u32 s28, 0
    s_cselect_b32 s48, s40, s42
    s_cselect_b32 s49, s41, s43
    s_mov_b32 s50, 1605632
    s_mov_b32 s51, 0x00020000
    buffer_load_dwordx2 a[16:17], v6, s[48:51], s34 offen
    s_add_u32 s34, s34, 3584
    buffer_load_dwordx2 a[18:19], v6, s[48:51], s34 offen
    s_add_u32 s34, s34, 3584
    buffer_load_dwordx2 a[20:21], v6, s[48:51], s34 offen
    s_add_u32 s34, s34, 3584
    buffer_load_dwordx2 a[22:23], v6, s[48:51], s34 offen
    s_add_u32 s34, s34, 3584
    buffer_load_dwordx2 a[24:25], v6, s[48:51], s34 offen
    s_add_u32 s34, s34, 3584
    buffer_load_dwordx2 a[26:27], v6, s[48:51], s34 offen
    s_add_u32 s34, s34, 3584
    buffer_load_dwordx2 a[28:29], v6, s[48:51], s34 offen
    s_add_u32 s34, s34, 3584
    buffer_load_dwordx2 a[30:31], v6, s[48:51], s34 offen
    s_branch RL_LX
RL_LD:
    v_lshlrev_b32 v6, 4, v1
    v_mov_b32 v7, 0x7ff00000
    v_cmp_gt_u32 vcc, 56, v1
    s_nop 1
    v_cndmask_b32 v6, v7, v6, vcc
    s_sub_u32 s10, s2, 218
    s_lshl_b32 s10, s10, 2
    s_add_u32 s10, s10, s3
    s_mul_i32 s24, s10, 7168
    s_mov_b32 s48, s44
    s_mov_b32 s49, s45
    s_mov_b32 s50, 1605632
    s_mov_b32 s51, 0x00020000
    buffer_load_dwordx4 a[0:3], v6, s[48:51], s24 offen offset:0
    buffer_load_dwordx4 a[4:7], v6, s[48:51], s24 offen offset:896
    buffer_load_dwordx4 a[8:11], v6, s[48:51], s24 offen offset:1792
    buffer_load_dwordx4 a[12:15], v6, s[48:51], s24 offen offset:2688
    s_add_u32 s24, s24, 3584
    buffer_load_dwordx4 a[16:19], v6, s[48:51], s24 offen offset:0
    buffer_load_dwordx4 a[20:23], v6, s[48:51], s24 offen offset:896
    buffer_load_dwordx4 a[24:27], v6, s[48:51], s24 offen offset:1792
    buffer_load_dwordx4 a[28:31], v6, s[48:51], s24 offen offset:2688
    s_add_u32 s24, s24, 799232
    buffer_load_dwordx4 a[32:35], v6, s[48:51], s24 offen offset:0
    buffer_load_dwordx4 a[36:39], v6, s[48:51], s24 offen offset:896
    buffer_load_dwordx4 a[40:43], v6, s[48:51], s24 offen offset:1792
    buffer_load_dwordx4 a[44:47], v6, s[48:51], s24 offen offset:2688
    s_add_u32 s24, s24, 3584
    buffer_load_dwordx4 a[48:51], v6, s[48:51], s24 offen offset:0
    buffer_load_dwordx4 a[52:55], v6, s[48:51], s24 offen offset:896
    buffer_load_dwordx4 a[56:59], v6, s[48:51], s24 offen offset:1792
    buffer_load_dwordx4 a[60:63], v6, s[48:51], s24 offen offset:2688
    s_add_u32 s24, s24, 799232
RL_LX:
    s_branch P3_G
P2_MAIN:
    s_lshr_b32 s10, s2, 3
    s_and_b32 s11, s2, 7
    s_lshl_b32 s28, s11, 2
    s_add_u32 s28, s28, s3
    s_lshl_b32 s33, s10, 17
    s_lshl_b32 s30, s11, 8
    s_add_u32 s33, s33, s30
    s_lshl_b32 s30, s3, 15
    s_add_u32 s33, s33, s30
    v_lshlrev_b32 v14, 11, v3
    v_lshl_add_u32 v14, v2, 4, v14
    v_lshlrev_b32 v15, 10, v3
    v_lshl_add_u32 v15, v2, 4, v15
    s_lshl_b32 s30, s3, 2
    s_add_u32 s30, s30, 16384
    v_add_u32 v15, s30, v15
    s_lshl_b32 s32, s3, 12
    s_add_u32 s32, s32, 16384
    v_mul_u32_u24 v6, 57600, v3
    v_lshl_add_u32 v6, v2, 1, v6
    s_mul_i32 s31, s28, 450
    s_lshl_b32 s30, s10, 5
    s_add_u32 s31, s31, s30
    s_mov_b32 s12, s6
    s_mov_b32 s13, s7
    s_mov_b32 s14, 1966080
    s_mov_b32 s15, 0x00020000
    s_mov_b32 s16, s56
    s_mov_b32 s17, s57
    s_mov_b32 s18, 921600
    s_mov_b32 s19, 0x00020000
    s_mov_b32 s20, s58
    s_mov_b32 s21, s59
    s_mov_b32 s22, 921600
    s_mov_b32 s23, 0x00020000
    s_add_u32 s24, s6, 2097152
    s_addc_u32 s25, s7, 0
    s_mov_b32 s26, 1966080
    s_mov_b32 s27, 0x00020000
    v_cvt_f32_u32 v8, v2
    v_mul_f32 v8, 0x3c800000, v8
    v_lshlrev_b32 v9, 2, v3
    v_cvt_f32_u32 v9, v9
    v_mul_f32 v9, v9, v8
    v_fmamk_f32 v10, v8, 0x00000000, v9
    v_cos_f32 v144, v10
    v_sin_f32 v160, v10
    v_mov_b32 v112, 0
    v_mov_b32 v128, 0
    buffer_load_short_d16_hi v112, v6, s[16:19], s31 offen
    buffer_load_short_d16_hi v128, v6, s[20:23], s31 offen
    s_add_u32 s31, s31, 14400
    v_fmamk_f32 v11, v8, 0x3f800000, v9
    v_cos_f32 v145, v11
    v_sin_f32 v161, v11
    v_fmamk_f32 v10, v8, 0x40000000, v9
    v_cos_f32 v146, v10
    v_sin_f32 v162, v10
    v_fmamk_f32 v11, v8, 0x40400000, v9
    v_cos_f32 v147, v11
    v_mov_b32 v113, 0
    v_mov_b32 v129, 0
    buffer_load_short_d16_hi v113, v6, s[16:19], s31 offen
    buffer_load_short_d16_hi v129, v6, s[20:23], s31 offen
    s_add_u32 s31, s31, 14400
    v_sin_f32 v163, v11
    v_fmamk_f32 v10, v8, 0x41800000, v9
    v_cos_f32 v148, v10
    v_sin_f32 v164, v10
    v_fmamk_f32 v11, v8, 0x41880000, v9
    v_cos_f32 v149, v11
    v_sin_f32 v165, v11
    v_fmamk_f32 v10, v8, 0x41900000, v9
    v_mov_b32 v114, 0
    v_mov_b32 v130, 0
    buffer_load_short_d16_hi v114, v6, s[16:19], s31 offen
    buffer_load_short_d16_hi v130, v6, s[20:23], s31 offen
    s_add_u32 s31, s31, 14400
    v_cos_f32 v150, v10
    v_sin_f32 v166, v10
    v_fmamk_f32 v11, v8, 0x41980000, v9
    v_cos_f32 v151, v11
    v_sin_f32 v167, v11
    v_fmamk_f32 v10, v8, 0x42000000, v9
    v_cos_f32 v152, v10
    v_sin_f32 v168, v10
    v_mov_b32 v115, 0
    v_mov_b32 v131, 0
    buffer_load_short_d16_hi v115, v6, s[16:19], s31 offen
    buffer_load_short_d16_hi v131, v6, s[20:23], s31 offen
    s_add_u32 s31, s31, 187200
    v_fmamk_f32 v11, v8, 0x42040000, v9
    v_cos_f32 v153, v11
    v_sin_f32 v169, v11
    v_fmamk_f32 v10, v8, 0x42080000, v9
    v_cos_f32 v154, v10
    v_sin_f32 v170, v10
    v_fmamk_f32 v11, v8, 0x420c0000, v9
    v_cos_f32 v155, v11
    v_mov_b32 v116, 0
    v_mov_b32 v132, 0
    buffer_load_short_d16_hi v116, v6, s[16:19], s31 offen
    buffer_load_short_d16_hi v132, v6, s[20:23], s31 offen
    s_add_u32 s31, s31, 14400
    v_sin_f32 v171, v11
    v_fmamk_f32 v10, v8, 0x42400000, v9
    v_cos_f32 v156, v10
    v_sin_f32 v172, v10
    v_fmamk_f32 v11, v8, 0x42440000, v9
    v_cos_f32 v157, v11
    v_sin_f32 v173, v11
    v_fmamk_f32 v10, v8, 0x42480000, v9
    v_mov_b32 v117, 0
    v_mov_b32 v133, 0
    buffer_load_short_d16_hi v117, v6, s[16:19], s31 offen
    buffer_load_short_d16_hi v133, v6, s[20:23], s31 offen
    s_add_u32 s31, s31, 14400
    v_cos_f32 v158, v10
    v_sin_f32 v174, v10
    v_fmamk_f32 v11, v8, 0x424c0000, v9
    v_cos_f32 v159, v11
    v_sin_f32 v175, v11
    v_cvt_pk_bf16_f32 v48, v144, v160
    v_cvt_pk_bf16_f32 v49, v145, v161
    v_cvt_pk_bf16_f32 v50, v146, v162
    v_mov_b32 v118, 0
    v_mov_b32 v134, 0
    buffer_load_short_d16_hi v118, v6, s[16:19], s31 offen
    buffer_load_short_d16_hi v134, v6, s[20:23], s31 offen
    s_add_u32 s31, s31, 14400
    v_cvt_pk_bf16_f32 v51, v147, v163
    v_cvt_pk_bf16_f32 v52, v148, v164
    v_cvt_pk_bf16_f32 v53, v149, v165
    v_cvt_pk_bf16_f32 v54, v150, v166
    v_cvt_pk_bf16_f32 v55, v151, v167
    v_cvt_pk_bf16_f32 v56, v152, v168
    v_cvt_pk_bf16_f32 v57, v153, v169
    v_cvt_pk_bf16_f32 v58, v154, v170
    v_mov_b32 v119, 0
    v_mov_b32 v135, 0
    buffer_load_short_d16_hi v119, v6, s[16:19], s31 offen
    buffer_load_short_d16_hi v135, v6, s[20:23], s31 offen
    s_add_u32 s31, s31, 187200
    v_cvt_pk_bf16_f32 v59, v155, v171
    v_cvt_pk_bf16_f32 v60, v156, v172
    v_cvt_pk_bf16_f32 v61, v157, v173
    v_cvt_pk_bf16_f32 v62, v158, v174
    v_cvt_pk_bf16_f32 v63, v159, v175
    v_cvt_pk_bf16_f32 v64, v144, v160
    v_cvt_pk_bf16_f32 v65, -v161, v145
    v_cvt_pk_bf16_f32 v66, -v146, -v162
    v_cvt_pk_bf16_f32 v67, v163, -v147
    v_cvt_pk_bf16_f32 v68, v148, v164
    v_cvt_pk_bf16_f32 v69, -v165, v149
    v_cvt_pk_bf16_f32 v70, -v150, -v166
    v_cvt_pk_bf16_f32 v71, v167, -v151
    v_cvt_pk_bf16_f32 v72, v152, v168
    v_cvt_pk_bf16_f32 v73, -v169, v153
    v_cvt_pk_bf16_f32 v74, -v154, -v170
    v_cvt_pk_bf16_f32 v75, v171, -v155
    v_cvt_pk_bf16_f32 v76, v156, v172
    v_cvt_pk_bf16_f32 v77, -v173, v157
    v_cvt_pk_bf16_f32 v78, -v158, -v174
    v_cvt_pk_bf16_f32 v79, v175, -v159
    v_cvt_pk_bf16_f32 v80, v144, v160
    v_cvt_pk_bf16_f32 v81, -v145, -v161
    v_cvt_pk_bf16_f32 v82, v146, v162
    v_cvt_pk_bf16_f32 v83, -v147, -v163
    v_cvt_pk_bf16_f32 v84, v148, v164
    v_cvt_pk_bf16_f32 v85, -v149, -v165
    v_cvt_pk_bf16_f32 v86, v150, v166
    v_cvt_pk_bf16_f32 v87, -v151, -v167
    v_cvt_pk_bf16_f32 v88, v152, v168
    v_cvt_pk_bf16_f32 v89, -v153, -v169
    v_cvt_pk_bf16_f32 v90, v154, v170
    v_cvt_pk_bf16_f32 v91, -v155, -v171
    v_cvt_pk_bf16_f32 v92, v156, v172
    v_cvt_pk_bf16_f32 v93, -v157, -v173
    v_cvt_pk_bf16_f32 v94, v158, v174
    v_cvt_pk_bf16_f32 v95, -v159, -v175
    v_cvt_pk_bf16_f32 v96, v144, v160
    v_cvt_pk_bf16_f32 v97, v161, -v145
    v_cvt_pk_bf16_f32 v98, -v146, -v162
    v_cvt_pk_bf16_f32 v99, -v163, v147
    v_cvt_pk_bf16_f32 v100, v148, v164
    v_cvt_pk_bf16_f32 v101, v165, -v149
    v_cvt_pk_bf16_f32 v102, -v150, -v166
    v_cvt_pk_bf16_f32 v103, -v167, v151
    v_cvt_pk_bf16_f32 v104, v152, v168
    v_cvt_pk_bf16_f32 v105, v169, -v153
    v_cvt_pk_bf16_f32 v106, -v154, -v170
    v_cvt_pk_bf16_f32 v107, -v171, v155
    v_cvt_pk_bf16_f32 v108, v156, v172
    v_cvt_pk_bf16_f32 v109, v173, -v157
    v_cvt_pk_bf16_f32 v110, -v158, -v174
    v_cvt_pk_bf16_f32 v111, -v175, v159
    s_mov_b32 s30, 0x80000000
    v_lshlrev_b32 v7, 10, v3
    v_lshl_add_u32 v7, v2, 4, v7
    s_lshl_b32 s29, s3, 2
    v_add_u32 v7, s29, v7
    v_lshlrev_b32 v5, 4, v1
    s_lshl_b32 s29, s3, 12
    v_add_u32 v5, s29, v5
    v_mul_u32_u24 v4, 30720, v3
    v_lshl_add_u32 v4, v2, 4, v4
    s_mul_i32 s29, s3, 491520
    s_lshl_b32 s35, s10, 11
    s_add_u32 s29, s29, s35
    s_lshl_b32 s35, s11, 8
    s_add_u32 s29, s29, s35
    s_cmp_lg_u32 s3, 0
    s_cbranch_scc1 E1_DONE
    v_lshlrev_b32 v13, 7, v3
    v_lshl_add_u32 v13, v2, 2, v13
    s_lshr_b32 s62, s10, 2
    s_lshl_b32 s62, s62, 9
    s_add_u32 s62, s62, 4096
    s_mov_b32 s63, 0
E1_LOOP:
    buffer_load_dword v12, v13, s[52:55], s62 offen sc1
    s_add_u32 s63, s63, 1
    s_waitcnt vmcnt(0)
    v_cmp_ne_u32 vcc, s96, v12
    s_nop 4
    s_cmp_eq_u64 vcc, 0
    s_cbranch_scc1 E1_DONE
    s_sleep 1
    s_cmp_lt_u32 s63, 0x40000
    s_cbranch_scc1 E1_LOOP
E1_DONE:
    s_barrier
    s_add_u32 m0, s32, 0
    s_add_u32 s30, s33, 0
    buffer_load_dwordx4 v14, s[12:15], s30 offen sc1 lds
    s_add_u32 m0, s32, 1024
    s_add_u32 s30, s33, 8192
    buffer_load_dwordx4 v14, s[12:15], s30 offen sc1 lds
    s_add_u32 m0, s32, 2048
    s_add_u32 s30, s33, 16384
    buffer_load_dwordx4 v14, s[12:15], s30 offen sc1 lds
    s_add_u32 m0, s32, 3072
    s_add_u32 s30, s33, 24576
    buffer_load_dwordx4 v14, s[12:15], s30 offen sc1 lds
    v_mov_b32 v120, 0
    v_mov_b32 v136, 0
    buffer_load_short_d16_hi v120, v6, s[16:19], s31 offen
    buffer_load_short_d16_hi v136, v6, s[20:23], s31 offen
    s_add_u32 s31, s31, 14400
    v_mov_b32 v121, 0
    v_mov_b32 v137, 0
    buffer_load_short_d16_hi v121, v6, s[16:19], s31 offen
    buffer_load_short_d16_hi v137, v6, s[20:23], s31 offen
    s_add_u32 s31, s31, 14400
    v_mov_b32 v122, 0
    v_mov_b32 v138, 0
    buffer_load_short_d16_hi v122, v6, s[16:19], s31 offen
    buffer_load_short_d16_hi v138, v6, s[20:23], s31 offen
    s_add_u32 s31, s31, 14400
    v_mov_b32 v123, 0
    v_mov_b32 v139, 0
    buffer_load_short_d16_hi v123, v6, s[16:19], s31 offen
    buffer_load_short_d16_hi v139, v6, s[20:23], s31 offen
    s_add_u32 s31, s31, 187200
    v_mov_b32 v124, 0
    v_mov_b32 v140, 0
    buffer_load_short_d16_hi v124, v6, s[16:19], s31 offen
    buffer_load_short_d16_hi v140, v6, s[20:23], s31 offen
    s_add_u32 s31, s31, 14400
    v_mov_b32 v125, 0
    v_mov_b32 v141, 0
    buffer_load_short_d16_hi v125, v6, s[16:19], s31 offen
    buffer_load_short_d16_hi v141, v6, s[20:23], s31 offen
    s_add_u32 s31, s31, 14400
    v_mov_b32 v126, 0
    v_mov_b32 v142, 0
    buffer_load_short_d16_hi v126, v6, s[16:19], s31 offen
    buffer_load_short_d16_hi v142, v6, s[20:23], s31 offen
    s_add_u32 s31, s31, 14400
    v_mov_b32 v127, 0
    v_mov_b32 v143, 0
    buffer_load_short_d16_hi v127, v6, s[16:19], s31 offen
    buffer_load_short_d16_hi v143, v6, s[20:23], s31 offen
    s_waitcnt vmcnt(16)
    s_barrier
    ds_read_b32 v16, v15 offset:0
    ds_read_b32 v17, v15 offset:256
    ds_read_b32 v18, v15 offset:512
    ds_read_b32 v19, v15 offset:768
    ds_read_b32 v20, v15 offset:4096
    ds_read_b32 v21, v15 offset:4352
    ds_read_b32 v22, v15 offset:4608
    ds_read_b32 v23, v15 offset:4864
    ds_read_b32 v24, v15 offset:8192
    ds_read_b32 v25, v15 offset:8448
    ds_read_b32 v26, v15 offset:8704
    ds_read_b32 v27, v15 offset:8960
    ds_read_b32 v28, v15 offset:12288
    ds_read_b32 v29, v15 offset:12544
    ds_read_b32 v30, v15 offset:12800
    ds_read_b32 v31, v15 offset:13056
    s_waitcnt lgkmcnt(0)
    s_mov_b32 s30, 0x80000000
    v_mfma_f32_16x16x32_bf16 v[144:147], v[48:51], v[16:19], 0
    v_alignbit_b32 v32, v16, v16, 16
    v_xor_b32 v32, s30, v32
    v_mfma_f32_16x16x32_bf16 v[148:151], v[64:67], v[16:19], 0
    v_alignbit_b32 v33, v17, v17, 16
    v_xor_b32 v33, s30, v33
    v_mfma_f32_16x16x32_bf16 v[152:155], v[80:83], v[16:19], 0
    v_alignbit_b32 v34, v18, v18, 16
    v_xor_b32 v34, s30, v34
    v_mfma_f32_16x16x32_bf16 v[156:159], v[96:99], v[16:19], 0
    v_alignbit_b32 v35, v19, v19, 16
    v_xor_b32 v35, s30, v35
    v_mfma_f32_16x16x32_bf16 v[144:147], v[52:55], v[20:23], v[144:147]
    v_alignbit_b32 v36, v20, v20, 16
    v_xor_b32 v36, s30, v36
    v_mfma_f32_16x16x32_bf16 v[148:151], v[68:71], v[20:23], v[148:151]
    v_alignbit_b32 v37, v21, v21, 16
    v_xor_b32 v37, s30, v37
    v_mfma_f32_16x16x32_bf16 v[152:155], v[84:87], v[20:23], v[152:155]
    v_alignbit_b32 v38, v22, v22, 16
    v_xor_b32 v38, s30, v38
    v_mfma_f32_16x16x32_bf16 v[156:159], v[100:103], v[20:23], v[156:159]
    v_alignbit_b32 v39, v23, v23, 16
    v_xor_b32 v39, s30, v39
    v_mfma_f32_16x16x32_bf16 v[144:147], v[56:59], v[24:27], v[144:147]
    v_alignbit_b32 v40, v24, v24, 16
    v_xor_b32 v40, s30, v40
    v_mfma_f32_16x16x32_bf16 v[148:151], v[72:75], v[24:27], v[148:151]
    v_alignbit_b32 v41, v25, v25, 16
    v_xor_b32 v41, s30, v41
    v_mfma_f32_16x16x32_bf16 v[152:155], v[88:91], v[24:27], v[152:155]
    v_alignbit_b32 v42, v26, v26, 16
    v_xor_b32 v42, s30, v42
    v_mfma_f32_16x16x32_bf16 v[156:159], v[104:107], v[24:27], v[156:159]
    v_alignbit_b32 v43, v27, v27, 16
    v_xor_b32 v43, s30, v43
    v_mfma_f32_16x16x32_bf16 v[144:147], v[60:63], v[28:31], v[144:147]
    v_alignbit_b32 v44, v28, v28, 16
    v_xor_b32 v44, s30, v44
    v_mfma_f32_16x16x32_bf16 v[148:151], v[76:79], v[28:31], v[148:151]
    v_alignbit_b32 v45, v29, v29, 16
    v_xor_b32 v45, s30, v45
    v_mfma_f32_16x16x32_bf16 v[152:155], v[92:95], v[28:31], v[152:155]
    v_alignbit_b32 v46, v30, v30, 16
    v_xor_b32 v46, s30, v46
    v_mfma_f32_16x16x32_bf16 v[156:159], v[108:111], v[28:31], v[156:159]
    v_alignbit_b32 v47, v31, v31, 16
    v_xor_b32 v47, s30, v47
    v_mfma_f32_16x16x32_bf16 v[160:163], v[48:51], v[32:35], 0
    v_mfma_f32_16x16x32_bf16 v[160:163], v[52:55], v[36:39], v[160:163]
    v_mfma_f32_16x16x32_bf16 v[160:163], v[56:59], v[40:43], v[160:163]
    v_mfma_f32_16x16x32_bf16 v[160:163], v[60:63], v[44:47], v[160:163]
    v_mfma_f32_16x16x32_bf16 v[164:167], v[64:67], v[32:35], 0
    v_mfma_f32_16x16x32_bf16 v[164:167], v[68:71], v[36:39], v[164:167]
    v_mfma_f32_16x16x32_bf16 v[164:167], v[72:75], v[40:43], v[164:167]
    v_mfma_f32_16x16x32_bf16 v[164:167], v[76:79], v[44:47], v[164:167]
    v_mfma_f32_16x16x32_bf16 v[168:171], v[80:83], v[32:35], 0
    v_mfma_f32_16x16x32_bf16 v[168:171], v[84:87], v[36:39], v[168:171]
    v_mfma_f32_16x16x32_bf16 v[168:171], v[88:91], v[40:43], v[168:171]
    v_mfma_f32_16x16x32_bf16 v[168:171], v[92:95], v[44:47], v[168:171]
    v_mfma_f32_16x16x32_bf16 v[172:175], v[96:99], v[32:35], 0
    v_mfma_f32_16x16x32_bf16 v[172:175], v[100:103], v[36:39], v[172:175]
    v_mfma_f32_16x16x32_bf16 v[172:175], v[104:107], v[40:43], v[172:175]
    v_mfma_f32_16x16x32_bf16 v[172:175], v[108:111], v[44:47], v[172:175]
    s_waitcnt vmcnt(0)
    v_pk_mul_f32 v[224:225], v[144:145], v[128:129]
    v_pk_mul_f32 v[208:209], v[144:145], v[112:113]
    v_pk_mul_f32 v[226:227], v[146:147], v[130:131]
    v_pk_mul_f32 v[210:211], v[146:147], v[114:115]
    v_pk_mul_f32 v[228:229], v[148:149], v[132:133]
    v_pk_mul_f32 v[212:213], v[148:149], v[116:117]
    v_pk_mul_f32 v[230:231], v[150:151], v[134:135]
    v_pk_mul_f32 v[214:215], v[150:151], v[118:119]
    v_pk_mul_f32 v[232:233], v[152:153], v[136:137]
    v_pk_mul_f32 v[216:217], v[152:153], v[120:121]
    v_pk_mul_f32 v[234:235], v[154:155], v[138:139]
    v_pk_mul_f32 v[218:219], v[154:155], v[122:123]
    v_pk_mul_f32 v[236:237], v[156:157], v[140:141]
    v_pk_mul_f32 v[220:221], v[156:157], v[124:125]
    v_pk_mul_f32 v[238:239], v[158:159], v[142:143]
    v_pk_mul_f32 v[222:223], v[158:159], v[126:127]
    v_pk_fma_f32 v[208:209], v[160:161], v[128:129], v[208:209] neg_lo:[1,0,0] neg_hi:[1,0,0]
    v_pk_fma_f32 v[224:225], v[160:161], v[112:113], v[224:225]
    v_cvt_pk_bf16_f32 v176, v208, -v224
    v_cvt_pk_bf16_f32 v192, v224, v208
    v_cvt_pk_bf16_f32 v177, v209, -v225
    v_cvt_pk_bf16_f32 v193, v225, v209
    v_pk_fma_f32 v[210:211], v[162:163], v[130:131], v[210:211] neg_lo:[1,0,0] neg_hi:[1,0,0]
    v_pk_fma_f32 v[226:227], v[162:163], v[114:115], v[226:227]
    v_cvt_pk_bf16_f32 v178, v210, -v226
    v_cvt_pk_bf16_f32 v194, v226, v210
    v_cvt_pk_bf16_f32 v179, v211, -v227
    v_cvt_pk_bf16_f32 v195, v227, v211
    v_pk_fma_f32 v[212:213], v[164:165], v[132:133], v[212:213] neg_lo:[1,0,0] neg_hi:[1,0,0]
    v_pk_fma_f32 v[228:229], v[164:165], v[116:117], v[228:229]
    v_cvt_pk_bf16_f32 v180, v212, -v228
    v_cvt_pk_bf16_f32 v196, v228, v212
    v_cvt_pk_bf16_f32 v181, v213, -v229
    v_cvt_pk_bf16_f32 v197, v229, v213
    v_pk_fma_f32 v[214:215], v[166:167], v[134:135], v[214:215] neg_lo:[1,0,0] neg_hi:[1,0,0]
    v_pk_fma_f32 v[230:231], v[166:167], v[118:119], v[230:231]
    v_cvt_pk_bf16_f32 v182, v214, -v230
    v_cvt_pk_bf16_f32 v198, v230, v214
    v_cvt_pk_bf16_f32 v183, v215, -v231
    v_cvt_pk_bf16_f32 v199, v231, v215
    v_pk_fma_f32 v[216:217], v[168:169], v[136:137], v[216:217] neg_lo:[1,0,0] neg_hi:[1,0,0]
    v_pk_fma_f32 v[232:233], v[168:169], v[120:121], v[232:233]
    v_cvt_pk_bf16_f32 v184, v216, -v232
    v_cvt_pk_bf16_f32 v200, v232, v216
    v_cvt_pk_bf16_f32 v185, v217, -v233
    v_cvt_pk_bf16_f32 v201, v233, v217
    v_pk_fma_f32 v[218:219], v[170:171], v[138:139], v[218:219] neg_lo:[1,0,0] neg_hi:[1,0,0]
    v_pk_fma_f32 v[234:235], v[170:171], v[122:123], v[234:235]
    v_cvt_pk_bf16_f32 v186, v218, -v234
    v_cvt_pk_bf16_f32 v202, v234, v218
    v_cvt_pk_bf16_f32 v187, v219, -v235
    v_cvt_pk_bf16_f32 v203, v235, v219
    v_pk_fma_f32 v[220:221], v[172:173], v[140:141], v[220:221] neg_lo:[1,0,0] neg_hi:[1,0,0]
    v_pk_fma_f32 v[236:237], v[172:173], v[124:125], v[236:237]
    v_cvt_pk_bf16_f32 v188, v220, -v236
    v_cvt_pk_bf16_f32 v204, v236, v220
    v_cvt_pk_bf16_f32 v189, v221, -v237
    v_cvt_pk_bf16_f32 v205, v237, v221
    v_pk_fma_f32 v[222:223], v[174:175], v[142:143], v[222:223] neg_lo:[1,0,0] neg_hi:[1,0,0]
    v_pk_fma_f32 v[238:239], v[174:175], v[126:127], v[238:239]
    v_cvt_pk_bf16_f32 v190, v222, -v238
    v_cvt_pk_bf16_f32 v206, v238, v222
    v_cvt_pk_bf16_f32 v191, v223, -v239
    v_cvt_pk_bf16_f32 v207, v239, v223
    v_mfma_f32_16x16x32_bf16 v[144:147], v[48:51], v[176:179], 0
    v_mfma_f32_16x16x32_bf16 v[160:163], v[48:51], v[192:195], 0
    v_mfma_f32_16x16x32_bf16 v[144:147], v[52:55], v[180:183], v[144:147]
    v_mfma_f32_16x16x32_bf16 v[160:163], v[52:55], v[196:199], v[160:163]
    v_mfma_f32_16x16x32_bf16 v[144:147], v[56:59], v[184:187], v[144:147]
    v_mfma_f32_16x16x32_bf16 v[160:163], v[56:59], v[200:203], v[160:163]
    v_mfma_f32_16x16x32_bf16 v[144:147], v[60:63], v[188:191], v[144:147]
    v_mfma_f32_16x16x32_bf16 v[160:163], v[60:63], v[204:207], v[160:163]
    v_mfma_f32_16x16x32_bf16 v[148:151], v[64:67], v[176:179], 0
    v_mfma_f32_16x16x32_bf16 v[164:167], v[64:67], v[192:195], 0
    s_nop 5
    v_cvt_pk_bf16_f32 v16, v144, v160
    ds_write_b32 v7, v16 offset:0
    v_mfma_f32_16x16x32_bf16 v[148:151], v[68:71], v[180:183], v[148:151]
    v_mfma_f32_16x16x32_bf16 v[164:167], v[68:71], v[196:199], v[164:167]
    v_cvt_pk_bf16_f32 v17, v145, v161
    ds_write_b32 v7, v17 offset:256
    v_mfma_f32_16x16x32_bf16 v[148:151], v[72:75], v[184:187], v[148:151]
    v_mfma_f32_16x16x32_bf16 v[164:167], v[72:75], v[200:203], v[164:167]
    v_cvt_pk_bf16_f32 v18, v146, v162
    ds_write_b32 v7, v18 offset:512
    v_mfma_f32_16x16x32_bf16 v[148:151], v[76:79], v[188:191], v[148:151]
    v_mfma_f32_16x16x32_bf16 v[164:167], v[76:79], v[204:207], v[164:167]
    v_cvt_pk_bf16_f32 v19, v147, v163
    ds_write_b32 v7, v19 offset:768
    v_mfma_f32_16x16x32_bf16 v[152:155], v[80:83], v[176:179], 0
    v_mfma_f32_16x16x32_bf16 v[168:171], v[80:83], v[192:195], 0
    s_nop 3
    v_cvt_pk_bf16_f32 v20, v148, v164
    ds_write_b32 v7, v20 offset:4096
    v_mfma_f32_16x16x32_bf16 v[152:155], v[84:87], v[180:183], v[152:155]
    v_mfma_f32_16x16x32_bf16 v[168:171], v[84:87], v[196:199], v[168:171]
    v_cvt_pk_bf16_f32 v21, v149, v165
    ds_write_b32 v7, v21 offset:4352
    v_mfma_f32_16x16x32_bf16 v[152:155], v[88:91], v[184:187], v[152:155]
    v_mfma_f32_16x16x32_bf16 v[168:171], v[88:91], v[200:203], v[168:171]
    v_cvt_pk_bf16_f32 v22, v150, v166
    ds_write_b32 v7, v22 offset:4608
    v_mfma_f32_16x16x32_bf16 v[152:155], v[92:95], v[188:191], v[152:155]
    v_mfma_f32_16x16x32_bf16 v[168:171], v[92:95], v[204:207], v[168:171]
    v_cvt_pk_bf16_f32 v23, v151, v167
    ds_write_b32 v7, v23 offset:4864
    v_mfma_f32_16x16x32_bf16 v[156:159], v[96:99], v[176:179], 0
    v_mfma_f32_16x16x32_bf16 v[172:175], v[96:99], v[192:195], 0
    s_nop 3
    v_cvt_pk_bf16_f32 v24, v152, v168
    ds_write_b32 v7, v24 offset:8192
    v_mfma_f32_16x16x32_bf16 v[156:159], v[100:103], v[180:183], v[156:159]
    v_mfma_f32_16x16x32_bf16 v[172:175], v[100:103], v[196:199], v[172:175]
    v_cvt_pk_bf16_f32 v25, v153, v169
    ds_write_b32 v7, v25 offset:8448
    v_mfma_f32_16x16x32_bf16 v[156:159], v[104:107], v[184:187], v[156:159]
    v_mfma_f32_16x16x32_bf16 v[172:175], v[104:107], v[200:203], v[172:175]
    v_cvt_pk_bf16_f32 v26, v154, v170
    ds_write_b32 v7, v26 offset:8704
    v_mfma_f32_16x16x32_bf16 v[156:159], v[108:111], v[188:191], v[156:159]
    v_mfma_f32_16x16x32_bf16 v[172:175], v[108:111], v[204:207], v[172:175]
    v_cvt_pk_bf16_f32 v27, v155, v171
    ds_write_b32 v7, v27 offset:8960
    s_nop 5
    v_cvt_pk_bf16_f32 v28, v156, v172
    ds_write_b32 v7, v28 offset:12288
    v_cvt_pk_bf16_f32 v29, v157, v173
    ds_write_b32 v7, v29 offset:12544
    v_cvt_pk_bf16_f32 v30, v158, v174
    ds_write_b32 v7, v30 offset:12800
    v_cvt_pk_bf16_f32 v31, v159, v175
    ds_write_b32 v7, v31 offset:13056
    s_waitcnt lgkmcnt(0)
    s_barrier
    ds_read_b128 v[32:35], v5 offset:0
    ds_read_b128 v[36:39], v5 offset:1024
    ds_read_b128 v[40:43], v5 offset:2048
    ds_read_b128 v[44:47], v5 offset:3072
    s_waitcnt lgkmcnt(3)
    buffer_store_dwordx4 v[32:35], v4, s[24:27], s29 offen sc1
    s_add_u32 s29, s29, 122880
    s_waitcnt lgkmcnt(2)
    buffer_store_dwordx4 v[36:39], v4, s[24:27], s29 offen sc1
    s_add_u32 s29, s29, 122880
    s_waitcnt lgkmcnt(1)
    buffer_store_dwordx4 v[40:43], v4, s[24:27], s29 offen sc1
    s_add_u32 s29, s29, 122880
    s_waitcnt lgkmcnt(0)
    buffer_store_dwordx4 v[44:47], v4, s[24:27], s29 offen sc1
    s_nop 7
    s_nop 7
    s_waitcnt vmcnt(0)
    s_barrier
    s_cmp_lg_u32 s3, 0
    s_cbranch_scc1 E2F_NF
    s_and_b32 s34, s2, 15
    s_lshl_b32 s34, s34, 7
    s_lshr_b32 s35, s2, 4
    s_lshl_b32 s35, s35, 2
    s_add_u32 s34, s34, s35
    s_add_u32 s34, s34, 8192
    v_mov_b32 v12, s96
    v_lshlrev_b32 v13, 11, v1
    v_cmp_gt_u32 vcc, 8, v1
    v_mov_b32 v11, 0x7ff00000
    s_nop 0
    v_cndmask_b32 v13, v11, v13, vcc
    buffer_store_dword v12, v13, s[52:55], s34 offen sc1
E2F_NF:
P3_G:
    s_load_dwordx2 s[56:57], s[0:1], 56
    s_lshr_b32 s11, s2, 5
    s_lshl_b32 s11, s11, 3
    s_and_b32 s9, s2, 7
    s_add_u32 s11, s11, s9
    s_bfe_u32 s10, s2, 0x10003
    s_bfe_u32 s9, s2, 0x10004
    s_lshl_b32 s8, s9, 2
    s_add_u32 s8, s8, s3
    s_lshl_b32 s32, s10, 10
    s_add_u32 s32, s32, s11
    v_lshlrev_b32 v6, 6, v2
    v_add_u32 v6, s32, v6
    v_cvt_f32_u32 v6, v6
    v_mul_f32 v6, 0x3a000000, v6
    v_lshlrev_b32 v7, 2, v3
    v_cvt_f32_u32 v7, v7
    v_mul_f32 v9, v7, v6
    v_fmamk_f32 v8, v6, 0x00000000, v9
    v_cos_f32 v10, v8
    v_sin_f32 v11, v8
    v_mul_f32 v10, 0x36124925, v10
    v_mul_f32 v11, 0x36124925, v11
    v_cvt_pk_bf16_f32 v48, v10, -v11
    v_cvt_pk_bf16_f32 v56, v11, v10
    v_fmamk_f32 v8, v6, 0x3f800000, v9
    v_cos_f32 v12, v8
    v_sin_f32 v13, v8
    v_mul_f32 v12, 0x36124925, v12
    v_mul_f32 v13, 0x36124925, v13
    v_cvt_pk_bf16_f32 v49, v12, -v13
    v_cvt_pk_bf16_f32 v57, v13, v12
    v_fmamk_f32 v8, v6, 0x40000000, v9
    v_cos_f32 v10, v8
    v_sin_f32 v11, v8
    v_mul_f32 v10, 0x36124925, v10
    v_mul_f32 v11, 0x36124925, v11
    v_cvt_pk_bf16_f32 v50, v10, -v11
    v_cvt_pk_bf16_f32 v58, v11, v10
    v_fmamk_f32 v8, v6, 0x40400000, v9
    v_cos_f32 v12, v8
    v_sin_f32 v13, v8
    v_mul_f32 v12, 0x36124925, v12
    v_mul_f32 v13, 0x36124925, v13
    v_cvt_pk_bf16_f32 v51, v12, -v13
    v_cvt_pk_bf16_f32 v59, v13, v12
    v_fmamk_f32 v8, v6, 0x41800000, v9
    v_cos_f32 v10, v8
    v_sin_f32 v11, v8
    v_mul_f32 v10, 0x36124925, v10
    v_mul_f32 v11, 0x36124925, v11
    v_cvt_pk_bf16_f32 v52, v10, -v11
    v_cvt_pk_bf16_f32 v60, v11, v10
    v_fmamk_f32 v8, v6, 0x41880000, v9
    v_cos_f32 v12, v8
    v_sin_f32 v13, v8
    v_mul_f32 v12, 0x36124925, v12
    v_mul_f32 v13, 0x36124925, v13
    v_cvt_pk_bf16_f32 v53, v12, -v13
    v_cvt_pk_bf16_f32 v61, v13, v12
    v_fmamk_f32 v8, v6, 0x41900000, v9
    v_cos_f32 v10, v8
    v_sin_f32 v11, v8
    v_mul_f32 v10, 0x36124925, v10
    v_mul_f32 v11, 0x36124925, v11
    v_cvt_pk_bf16_f32 v54, v10, -v11
    v_cvt_pk_bf16_f32 v62, v11, v10
    v_fmamk_f32 v8, v6, 0x41980000, v9
    v_cos_f32 v12, v8
    v_sin_f32 v13, v8
    v_mul_f32 v12, 0x36124925, v12
    v_mul_f32 v13, 0x36124925, v13
    v_cvt_pk_bf16_f32 v55, v12, -v13
    v_cvt_pk_bf16_f32 v63, v13, v12
    v_lshlrev_b32 v14, 4, v1
    s_lshl_b32 s32, s3, 10
    v_add_u32 v15, s32, v14
    v_lshrrev_b32 v6, 2, v2
    v_lshlrev_b32 v6, 3, v6
    v_and_b32 v8, 3, v2
    v_add_u32 v6, v6, v8
    s_lshl_b32 s32, s8, 5
    v_add_u32 v6, s32, v6
    v_cvt_f32_u32 v6, v6
    v_cmp_eq_u32 vcc, 0, v3
    s_nop 1
    v_cndmask_b32 v248, 1.0, 0.5, vcc
    v_cndmask_b32 v249, 0, 0.5, vcc
    v_mul_f32 v8, 0x3b124925, v6
    v_mul_f32 v9, v7, v8
    v_mul_f32 v12, 0x3d924925, v6
    v_cos_f32 v12, v12
    s_nop 0
    v_add_f32 v12, v12, v12
    v_mov_b32 v13, v12
    v_fmamk_f32 v10, v8, 0x00000000, v9
    v_cos_f32 v200, v10
    v_sin_f32 v201, -v10
    v_fmamk_f32 v11, v8, 0x40000000, v9
    v_cos_f32 v202, v11
    v_sin_f32 v203, -v11
    v_fmamk_f32 v10, v8, 0x41800000, v9
    v_cos_f32 v204, v10
    v_sin_f32 v205, -v10
    v_fmamk_f32 v11, v8, 0x41900000, v9
    v_cos_f32 v206, v11
    v_sin_f32 v207, -v11
    v_fmamk_f32 v10, v8, 0x3f800000, v9
    v_cos_f32 v208, v10
    v_sin_f32 v209, -v10
    v_fmamk_f32 v11, v8, 0x40400000, v9
    v_cos_f32 v210, v11
    v_sin_f32 v211, -v11
    v_fmamk_f32 v10, v8, 0x41880000, v9
    v_cos_f32 v212, v10
    v_sin_f32 v213, -v10
    v_fmamk_f32 v11, v8, 0x41980000, v9
    v_cos_f32 v214, v11
    v_sin_f32 v215, -v11
    v_fmamk_f32 v10, v8, 0x42000000, v9
    v_cos_f32 v216, v10
    v_sin_f32 v217, -v10
    v_fmamk_f32 v11, v8, 0x42080000, v9
    v_cos_f32 v218, v11
    v_sin_f32 v219, -v11
    v_fmamk_f32 v10, v8, 0x42400000, v9
    v_cos_f32 v220, v10
    v_sin_f32 v221, -v10
    v_fmamk_f32 v11, v8, 0x42480000, v9
    v_cos_f32 v222, v11
    v_sin_f32 v223, -v11
    v_fmamk_f32 v10, v8, 0x42040000, v9
    v_cos_f32 v224, v10
    v_sin_f32 v225, -v10
    v_fmamk_f32 v11, v8, 0x420c0000, v9
    v_cos_f32 v226, v11
    v_sin_f32 v227, -v11
    v_fmamk_f32 v10, v8, 0x42440000, v9
    v_cos_f32 v228, v10
    v_sin_f32 v229, -v10
    v_fmamk_f32 v11, v8, 0x424c0000, v9
    v_cos_f32 v230, v11
    v_sin_f32 v231, -v11
    v_mul_f32 v10, v200, v248
    v_cvt_pk_bf16_f32 v80, v10, v201
    v_cvt_pk_bf16_f32 v81, v202, v203
    v_cvt_pk_bf16_f32 v82, v204, v205
    v_cvt_pk_bf16_f32 v83, v206, v207
    v_cvt_pk_bf16_f32 v112, v208, v209
    v_cvt_pk_bf16_f32 v113, v210, v211
    v_cvt_pk_bf16_f32 v114, v212, v213
    v_cvt_pk_bf16_f32 v115, v214, v215
    v_cvt_pk_bf16_f32 v84, v216, v217
    v_cvt_pk_bf16_f32 v85, v218, v219
    v_cvt_pk_bf16_f32 v86, v220, v221
    v_cvt_pk_bf16_f32 v87, v222, v223
    v_cvt_pk_bf16_f32 v116, v224, v225
    v_cvt_pk_bf16_f32 v117, v226, v227
    v_cvt_pk_bf16_f32 v118, v228, v229
    v_cvt_pk_bf16_f32 v119, v230, v231
    v_pk_fma_f32 v[200:201], v[12:13], v[216:217], v[200:201] neg_lo:[0,0,1] neg_hi:[0,0,1]
    v_pk_fma_f32 v[202:203], v[12:13], v[218:219], v[202:203] neg_lo:[0,0,1] neg_hi:[0,0,1]
    v_pk_fma_f32 v[204:205], v[12:13], v[220:221], v[204:205] neg_lo:[0,0,1] neg_hi:[0,0,1]
    v_pk_fma_f32 v[206:207], v[12:13], v[222:223], v[206:207] neg_lo:[0,0,1] neg_hi:[0,0,1]
    v_pk_fma_f32 v[208:209], v[12:13], v[224:225], v[208:209] neg_lo:[0,0,1] neg_hi:[0,0,1]
    v_pk_fma_f32 v[210:211], v[12:13], v[226:227], v[210:211] neg_lo:[0,0,1] neg_hi:[0,0,1]
    v_pk_fma_f32 v[212:213], v[12:13], v[228:229], v[212:213] neg_lo:[0,0,1] neg_hi:[0,0,1]
    v_pk_fma_f32 v[214:215], v[12:13], v[230:231], v[214:215] neg_lo:[0,0,1] neg_hi:[0,0,1]
    v_cvt_pk_bf16_f32 v88, v200, v201
    v_cvt_pk_bf16_f32 v89, v202, v203
    v_cvt_pk_bf16_f32 v90, v204, v205
    v_cvt_pk_bf16_f32 v91, v206, v207
    v_cvt_pk_bf16_f32 v120, v208, v209
    v_cvt_pk_bf16_f32 v121, v210, v211
    v_cvt_pk_bf16_f32 v122, v212, v213
    v_cvt_pk_bf16_f32 v123, v214, v215
    v_pk_fma_f32 v[216:217], v[12:13], v[200:201], v[216:217] neg_lo:[0,0,1] neg_hi:[0,0,1]
    v_pk_fma_f32 v[218:219], v[12:13], v[202:203], v[218:219] neg_lo:[0,0,1] neg_hi:[0,0,1]
    v_pk_fma_f32 v[220:221], v[12:13], v[204:205], v[220:221] neg_lo:[0,0,1] neg_hi:[0,0,1]
    v_pk_fma_f32 v[222:223], v[12:13], v[206:207], v[222:223] neg_lo:[0,0,1] neg_hi:[0,0,1]
    v_pk_fma_f32 v[224:225], v[12:13], v[208:209], v[224:225] neg_lo:[0,0,1] neg_hi:[0,0,1]
    v_pk_fma_f32 v[226:227], v[12:13], v[210:211], v[226:227] neg_lo:[0,0,1] neg_hi:[0,0,1]
    v_pk_fma_f32 v[228:229], v[12:13], v[212:213], v[228:229] neg_lo:[0,0,1] neg_hi:[0,0,1]
    v_pk_fma_f32 v[230:231], v[12:13], v[214:215], v[230:231] neg_lo:[0,0,1] neg_hi:[0,0,1]
    v_cvt_pk_bf16_f32 v92, v216, v217
    v_cvt_pk_bf16_f32 v93, v218, v219
    v_cvt_pk_bf16_f32 v94, v220, v221
    v_cvt_pk_bf16_f32 v95, v222, v223
    v_cvt_pk_bf16_f32 v124, v224, v225
    v_cvt_pk_bf16_f32 v125, v226, v227
    v_cvt_pk_bf16_f32 v126, v228, v229
    v_cvt_pk_bf16_f32 v127, v230, v231
    v_pk_fma_f32 v[200:201], v[12:13], v[216:217], v[200:201] neg_lo:[0,0,1] neg_hi:[0,0,1]
    v_pk_fma_f32 v[202:203], v[12:13], v[218:219], v[202:203] neg_lo:[0,0,1] neg_hi:[0,0,1]
    v_pk_fma_f32 v[204:205], v[12:13], v[220:221], v[204:205] neg_lo:[0,0,1] neg_hi:[0,0,1]
    v_pk_fma_f32 v[206:207], v[12:13], v[222:223], v[206:207] neg_lo:[0,0,1] neg_hi:[0,0,1]
    v_pk_fma_f32 v[208:209], v[12:13], v[224:225], v[208:209] neg_lo:[0,0,1] neg_hi:[0,0,1]
    v_pk_fma_f32 v[210:211], v[12:13], v[226:227], v[210:211] neg_lo:[0,0,1] neg_hi:[0,0,1]
    v_pk_fma_f32 v[212:213], v[12:13], v[228:229], v[212:213] neg_lo:[0,0,1] neg_hi:[0,0,1]
    v_pk_fma_f32 v[214:215], v[12:13], v[230:231], v[214:215] neg_lo:[0,0,1] neg_hi:[0,0,1]
    v_cvt_pk_bf16_f32 v96, v200, v201
    v_cvt_pk_bf16_f32 v97, v202, v203
    v_cvt_pk_bf16_f32 v98, v204, v205
    v_cvt_pk_bf16_f32 v99, v206, v207
    v_cvt_pk_bf16_f32 v128, v208, v209
    v_cvt_pk_bf16_f32 v129, v210, v211
    v_cvt_pk_bf16_f32 v130, v212, v213
    v_cvt_pk_bf16_f32 v131, v214, v215
    v_pk_fma_f32 v[216:217], v[12:13], v[200:201], v[216:217] neg_lo:[0,0,1] neg_hi:[0,0,1]
    v_pk_fma_f32 v[218:219], v[12:13], v[202:203], v[218:219] neg_lo:[0,0,1] neg_hi:[0,0,1]
    v_pk_fma_f32 v[220:221], v[12:13], v[204:205], v[220:221] neg_lo:[0,0,1] neg_hi:[0,0,1]
    v_pk_fma_f32 v[222:223], v[12:13], v[206:207], v[222:223] neg_lo:[0,0,1] neg_hi:[0,0,1]
    v_pk_fma_f32 v[224:225], v[12:13], v[208:209], v[224:225] neg_lo:[0,0,1] neg_hi:[0,0,1]
    v_pk_fma_f32 v[226:227], v[12:13], v[210:211], v[226:227] neg_lo:[0,0,1] neg_hi:[0,0,1]
    v_pk_fma_f32 v[228:229], v[12:13], v[212:213], v[228:229] neg_lo:[0,0,1] neg_hi:[0,0,1]
    v_pk_fma_f32 v[230:231], v[12:13], v[214:215], v[230:231] neg_lo:[0,0,1] neg_hi:[0,0,1]
    v_cvt_pk_bf16_f32 v100, v216, v217
    v_cvt_pk_bf16_f32 v101, v218, v219
    v_cvt_pk_bf16_f32 v102, v220, v221
    v_cvt_pk_bf16_f32 v103, v222, v223
    v_cvt_pk_bf16_f32 v132, v224, v225
    v_cvt_pk_bf16_f32 v133, v226, v227
    v_cvt_pk_bf16_f32 v134, v228, v229
    v_cvt_pk_bf16_f32 v135, v230, v231
    v_pk_fma_f32 v[200:201], v[12:13], v[216:217], v[200:201] neg_lo:[0,0,1] neg_hi:[0,0,1]
    v_pk_fma_f32 v[202:203], v[12:13], v[218:219], v[202:203] neg_lo:[0,0,1] neg_hi:[0,0,1]
    v_pk_fma_f32 v[204:205], v[12:13], v[220:221], v[204:205] neg_lo:[0,0,1] neg_hi:[0,0,1]
    v_pk_fma_f32 v[206:207], v[12:13], v[222:223], v[206:207] neg_lo:[0,0,1] neg_hi:[0,0,1]
    v_pk_fma_f32 v[208:209], v[12:13], v[224:225], v[208:209] neg_lo:[0,0,1] neg_hi:[0,0,1]
    v_pk_fma_f32 v[210:211], v[12:13], v[226:227], v[210:211] neg_lo:[0,0,1] neg_hi:[0,0,1]
    v_pk_fma_f32 v[212:213], v[12:13], v[228:229], v[212:213] neg_lo:[0,0,1] neg_hi:[0,0,1]
    v_pk_fma_f32 v[214:215], v[12:13], v[230:231], v[214:215] neg_lo:[0,0,1] neg_hi:[0,0,1]
    v_cvt_pk_bf16_f32 v104, v200, v201
    v_cvt_pk_bf16_f32 v105, v202, v203
    v_cvt_pk_bf16_f32 v106, v204, v205
    v_cvt_pk_bf16_f32 v107, v206, v207
    v_cvt_pk_bf16_f32 v136, v208, v209
    v_cvt_pk_bf16_f32 v137, v210, v211
    v_cvt_pk_bf16_f32 v138, v212, v213
    v_cvt_pk_bf16_f32 v139, v214, v215
    v_mul_f32 v10, 0.5, v6
    v_cos_f32 v10, v10
    s_nop 0
    v_mul_f32 v10, v10, v249
    v_cvt_pk_bf16_f32 v108, v10, 0
    v_mov_b32 v109, 0
    v_mov_b32 v110, 0
    v_mov_b32 v111, 0
    v_add_f32 v6, 4.0, v6
    v_mul_f32 v8, 0x3b124925, v6
    v_mul_f32 v9, v7, v8
    v_mul_f32 v12, 0x3d924925, v6
    v_cos_f32 v12, v12
    s_nop 0
    v_add_f32 v12, v12, v12
    v_mov_b32 v13, v12
    v_fmamk_f32 v10, v8, 0x00000000, v9
    v_cos_f32 v200, v10
    v_sin_f32 v201, -v10
    v_fmamk_f32 v11, v8, 0x40000000, v9
    v_cos_f32 v202, v11
    v_sin_f32 v203, -v11
    v_fmamk_f32 v10, v8, 0x41800000, v9
    v_cos_f32 v204, v10
    v_sin_f32 v205, -v10
    v_fmamk_f32 v11, v8, 0x41900000, v9
    v_cos_f32 v206, v11
    v_sin_f32 v207, -v11
    v_fmamk_f32 v10, v8, 0x3f800000, v9
    v_cos_f32 v208, v10
    v_sin_f32 v209, -v10
    v_fmamk_f32 v11, v8, 0x40400000, v9
    v_cos_f32 v210, v11
    v_sin_f32 v211, -v11
    v_fmamk_f32 v10, v8, 0x41880000, v9
    v_cos_f32 v212, v10
    v_sin_f32 v213, -v10
    v_fmamk_f32 v11, v8, 0x41980000, v9
    v_cos_f32 v214, v11
    v_sin_f32 v215, -v11
    v_fmamk_f32 v10, v8, 0x42000000, v9
    v_cos_f32 v216, v10
    v_sin_f32 v217, -v10
    v_fmamk_f32 v11, v8, 0x42080000, v9
    v_cos_f32 v218, v11
    v_sin_f32 v219, -v11
    v_fmamk_f32 v10, v8, 0x42400000, v9
    v_cos_f32 v220, v10
    v_sin_f32 v221, -v10
    v_fmamk_f32 v11, v8, 0x42480000, v9
    v_cos_f32 v222, v11
    v_sin_f32 v223, -v11
    v_fmamk_f32 v10, v8, 0x42040000, v9
    v_cos_f32 v224, v10
    v_sin_f32 v225, -v10
    v_fmamk_f32 v11, v8, 0x420c0000, v9
    v_cos_f32 v226, v11
    v_sin_f32 v227, -v11
    v_fmamk_f32 v10, v8, 0x42440000, v9
    v_cos_f32 v228, v10
    v_sin_f32 v229, -v10
    v_fmamk_f32 v11, v8, 0x424c0000, v9
    v_cos_f32 v230, v11
    v_sin_f32 v231, -v11
    v_mul_f32 v10, v200, v248
    v_cvt_pk_bf16_f32 v140, v10, v201
    v_cvt_pk_bf16_f32 v141, v202, v203
    v_cvt_pk_bf16_f32 v142, v204, v205
    v_cvt_pk_bf16_f32 v143, v206, v207
    v_cvt_pk_bf16_f32 v172, v208, v209
    v_cvt_pk_bf16_f32 v173, v210, v211
    v_cvt_pk_bf16_f32 v174, v212, v213
    v_cvt_pk_bf16_f32 v175, v214, v215
    v_cvt_pk_bf16_f32 v144, v216, v217
    v_cvt_pk_bf16_f32 v145, v218, v219
    v_cvt_pk_bf16_f32 v146, v220, v221
    v_cvt_pk_bf16_f32 v147, v222, v223
    v_cvt_pk_bf16_f32 v176, v224, v225
    v_cvt_pk_bf16_f32 v177, v226, v227
    v_cvt_pk_bf16_f32 v178, v228, v229
    v_cvt_pk_bf16_f32 v179, v230, v231
    v_pk_fma_f32 v[200:201], v[12:13], v[216:217], v[200:201] neg_lo:[0,0,1] neg_hi:[0,0,1]
    v_pk_fma_f32 v[202:203], v[12:13], v[218:219], v[202:203] neg_lo:[0,0,1] neg_hi:[0,0,1]
    v_pk_fma_f32 v[204:205], v[12:13], v[220:221], v[204:205] neg_lo:[0,0,1] neg_hi:[0,0,1]
    v_pk_fma_f32 v[206:207], v[12:13], v[222:223], v[206:207] neg_lo:[0,0,1] neg_hi:[0,0,1]
    v_pk_fma_f32 v[208:209], v[12:13], v[224:225], v[208:209] neg_lo:[0,0,1] neg_hi:[0,0,1]
    v_pk_fma_f32 v[210:211], v[12:13], v[226:227], v[210:211] neg_lo:[0,0,1] neg_hi:[0,0,1]
    v_pk_fma_f32 v[212:213], v[12:13], v[228:229], v[212:213] neg_lo:[0,0,1] neg_hi:[0,0,1]
    v_pk_fma_f32 v[214:215], v[12:13], v[230:231], v[214:215] neg_lo:[0,0,1] neg_hi:[0,0,1]
    v_cvt_pk_bf16_f32 v148, v200, v201
    v_cvt_pk_bf16_f32 v149, v202, v203
    v_cvt_pk_bf16_f32 v150, v204, v205
    v_cvt_pk_bf16_f32 v151, v206, v207
    v_cvt_pk_bf16_f32 v180, v208, v209
    v_cvt_pk_bf16_f32 v181, v210, v211
    v_cvt_pk_bf16_f32 v182, v212, v213
    v_cvt_pk_bf16_f32 v183, v214, v215
    v_pk_fma_f32 v[216:217], v[12:13], v[200:201], v[216:217] neg_lo:[0,0,1] neg_hi:[0,0,1]
    v_pk_fma_f32 v[218:219], v[12:13], v[202:203], v[218:219] neg_lo:[0,0,1] neg_hi:[0,0,1]
    v_pk_fma_f32 v[220:221], v[12:13], v[204:205], v[220:221] neg_lo:[0,0,1] neg_hi:[0,0,1]
    v_pk_fma_f32 v[222:223], v[12:13], v[206:207], v[222:223] neg_lo:[0,0,1] neg_hi:[0,0,1]
    v_pk_fma_f32 v[224:225], v[12:13], v[208:209], v[224:225] neg_lo:[0,0,1] neg_hi:[0,0,1]
    v_pk_fma_f32 v[226:227], v[12:13], v[210:211], v[226:227] neg_lo:[0,0,1] neg_hi:[0,0,1]
    v_pk_fma_f32 v[228:229], v[12:13], v[212:213], v[228:229] neg_lo:[0,0,1] neg_hi:[0,0,1]
    v_pk_fma_f32 v[230:231], v[12:13], v[214:215], v[230:231] neg_lo:[0,0,1] neg_hi:[0,0,1]
    v_cvt_pk_bf16_f32 v152, v216, v217
    v_cvt_pk_bf16_f32 v153, v218, v219
    v_cvt_pk_bf16_f32 v154, v220, v221
    v_cvt_pk_bf16_f32 v155, v222, v223
    v_cvt_pk_bf16_f32 v184, v224, v225
    v_cvt_pk_bf16_f32 v185, v226, v227
    v_cvt_pk_bf16_f32 v186, v228, v229
    v_cvt_pk_bf16_f32 v187, v230, v231
    v_pk_fma_f32 v[200:201], v[12:13], v[216:217], v[200:201] neg_lo:[0,0,1] neg_hi:[0,0,1]
    v_pk_fma_f32 v[202:203], v[12:13], v[218:219], v[202:203] neg_lo:[0,0,1] neg_hi:[0,0,1]
    v_pk_fma_f32 v[204:205], v[12:13], v[220:221], v[204:205] neg_lo:[0,0,1] neg_hi:[0,0,1]
    v_pk_fma_f32 v[206:207], v[12:13], v[222:223], v[206:207] neg_lo:[0,0,1] neg_hi:[0,0,1]
    v_pk_fma_f32 v[208:209], v[12:13], v[224:225], v[208:209] neg_lo:[0,0,1] neg_hi:[0,0,1]
    v_pk_fma_f32 v[210:211], v[12:13], v[226:227], v[210:211] neg_lo:[0,0,1] neg_hi:[0,0,1]
    v_pk_fma_f32 v[212:213], v[12:13], v[228:229], v[212:213] neg_lo:[0,0,1] neg_hi:[0,0,1]
    v_pk_fma_f32 v[214:215], v[12:13], v[230:231], v[214:215] neg_lo:[0,0,1] neg_hi:[0,0,1]
    v_cvt_pk_bf16_f32 v156, v200, v201
    v_cvt_pk_bf16_f32 v157, v202, v203
    v_cvt_pk_bf16_f32 v158, v204, v205
    v_cvt_pk_bf16_f32 v159, v206, v207
    v_cvt_pk_bf16_f32 v188, v208, v209
    v_cvt_pk_bf16_f32 v189, v210, v211
    v_cvt_pk_bf16_f32 v190, v212, v213
    v_cvt_pk_bf16_f32 v191, v214, v215
    v_pk_fma_f32 v[216:217], v[12:13], v[200:201], v[216:217] neg_lo:[0,0,1] neg_hi:[0,0,1]
    v_pk_fma_f32 v[218:219], v[12:13], v[202:203], v[218:219] neg_lo:[0,0,1] neg_hi:[0,0,1]
    v_pk_fma_f32 v[220:221], v[12:13], v[204:205], v[220:221] neg_lo:[0,0,1] neg_hi:[0,0,1]
    v_pk_fma_f32 v[222:223], v[12:13], v[206:207], v[222:223] neg_lo:[0,0,1] neg_hi:[0,0,1]
    v_pk_fma_f32 v[224:225], v[12:13], v[208:209], v[224:225] neg_lo:[0,0,1] neg_hi:[0,0,1]
    v_pk_fma_f32 v[226:227], v[12:13], v[210:211], v[226:227] neg_lo:[0,0,1] neg_hi:[0,0,1]
    v_pk_fma_f32 v[228:229], v[12:13], v[212:213], v[228:229] neg_lo:[0,0,1] neg_hi:[0,0,1]
    v_pk_fma_f32 v[230:231], v[12:13], v[214:215], v[230:231] neg_lo:[0,0,1] neg_hi:[0,0,1]
    v_cvt_pk_bf16_f32 v160, v216, v217
    v_cvt_pk_bf16_f32 v161, v218, v219
    v_cvt_pk_bf16_f32 v162, v220, v221
    v_cvt_pk_bf16_f32 v163, v222, v223
    v_cvt_pk_bf16_f32 v192, v224, v225
    v_cvt_pk_bf16_f32 v193, v226, v227
    v_cvt_pk_bf16_f32 v194, v228, v229
    v_cvt_pk_bf16_f32 v195, v230, v231
    v_pk_fma_f32 v[200:201], v[12:13], v[216:217], v[200:201] neg_lo:[0,0,1] neg_hi:[0,0,1]
    v_pk_fma_f32 v[202:203], v[12:13], v[218:219], v[202:203] neg_lo:[0,0,1] neg_hi:[0,0,1]
    v_pk_fma_f32 v[204:205], v[12:13], v[220:221], v[204:205] neg_lo:[0,0,1] neg_hi:[0,0,1]
    v_pk_fma_f32 v[206:207], v[12:13], v[222:223], v[206:207] neg_lo:[0,0,1] neg_hi:[0,0,1]
    v_pk_fma_f32 v[208:209], v[12:13], v[224:225], v[208:209] neg_lo:[0,0,1] neg_hi:[0,0,1]
    v_pk_fma_f32 v[210:211], v[12:13], v[226:227], v[210:211] neg_lo:[0,0,1] neg_hi:[0,0,1]
    v_pk_fma_f32 v[212:213], v[12:13], v[228:229], v[212:213] neg_lo:[0,0,1] neg_hi:[0,0,1]
    v_pk_fma_f32 v[214:215], v[12:13], v[230:231], v[214:215] neg_lo:[0,0,1] neg_hi:[0,0,1]
    v_cvt_pk_bf16_f32 v164, v200, v201
    v_cvt_pk_bf16_f32 v165, v202, v203
    v_cvt_pk_bf16_f32 v166, v204, v205
    v_cvt_pk_bf16_f32 v167, v206, v207
    v_cvt_pk_bf16_f32 v196, v208, v209
    v_cvt_pk_bf16_f32 v197, v210, v211
    v_cvt_pk_bf16_f32 v198, v212, v213
    v_cvt_pk_bf16_f32 v199, v214, v215
    v_mul_f32 v10, 0.5, v6
    v_cos_f32 v10, v10
    s_nop 0
    v_mul_f32 v10, v10, v249
    v_cvt_pk_bf16_f32 v168, v10, 0
    v_mov_b32 v169, 0
    v_mov_b32 v170, 0
    v_mov_b32 v171, 0
    s_sub_u32 s33, s2, 120
    s_cmp_ge_u32 s33, 126
    s_cbranch_scc1 RL_RET
    s_mov_b32 s30, 0x05040100
    s_mov_b32 s31, 0x07060302
    s_lshl_b32 s33, s3, 13
    s_add_u32 s33, s33, 32768
    s_cmp_ge_u32 s2, 218
    s_cbranch_scc1 RL_SD
    s_add_u32 s20, s6, 8388608
    s_addc_u32 s21, s7, 0
    s_mov_b32 s22, 3211264
    s_mov_b32 s23, 0x00020000
    v_lshrrev_b32 v5, 3, v1
    v_lshlrev_b32 v4, 9, v5
    v_bfe_u32 v6, v1, 2, 1
    v_lshl_add_u32 v4, v6, 8, v4
    v_and_b32 v6, 1, v1
    v_lshl_add_u32 v4, v6, 7, v4
    v_bfe_u32 v6, v1, 1, 1
    v_lshl_add_u32 v4, v6, 6, v4
    v_add_u32 v4, s33, v4
    v_and_b32 v6, 7, v1
    v_lshlrev_b32 v6, 4, v6
    v_lshl_add_u32 v7, v5, 9, v6
    v_add_u32 v7, s33, v7
    v_mul_u32_u24 v5, 57344, v5
    v_add_u32 v5, v5, v6
    s_waitcnt vmcnt(0)
    v_accvgpr_read_b32 v16, a0
    v_accvgpr_read_b32 v17, a1
    v_accvgpr_read_b32 v18, a2
    v_accvgpr_read_b32 v19, a3
    v_accvgpr_read_b32 v20, a4
    v_accvgpr_read_b32 v21, a5
    v_accvgpr_read_b32 v22, a6
    v_accvgpr_read_b32 v23, a7
    v_accvgpr_read_b32 v24, a8
    v_accvgpr_read_b32 v25, a9
    v_accvgpr_read_b32 v26, a10
    v_accvgpr_read_b32 v27, a11
    v_accvgpr_read_b32 v28, a12
    v_accvgpr_read_b32 v29, a13
    v_accvgpr_read_b32 v30, a14
    v_accvgpr_read_b32 v31, a15
    v_perm_b32 v32, v18, v16, s30
    v_perm_b32 v33, v22, v20, s30
    v_perm_b32 v34, v26, v24, s30
    v_perm_b32 v35, v30, v28, s30
    ds_write_b128 v4, v[32:35] offset:0
    v_perm_b32 v36, v18, v16, s31
    v_perm_b32 v37, v22, v20, s31
    v_perm_b32 v38, v26, v24, s31
    v_perm_b32 v39, v30, v28, s31
    ds_write_b128 v4, v[36:39] offset:16
    v_perm_b32 v40, v19, v17, s30
    v_perm_b32 v41, v23, v21, s30
    v_perm_b32 v42, v27, v25, s30
    v_perm_b32 v43, v31, v29, s30
    ds_write_b128 v4, v[40:43] offset:32
    v_perm_b32 v44, v19, v17, s31
    v_perm_b32 v45, v23, v21, s31
    v_perm_b32 v46, v27, v25, s31
    v_perm_b32 v47, v31, v29, s31
    ds_write_b128 v4, v[44:47] offset:48
    s_sub_u32 s11, s2, 120
    s_lshl_b32 s11, s11, 2
    s_add_u32 s11, s11, s3
    s_mul_hi_u32 s24, s11, 613566757
    s_mul_i32 s25, s24, 7
    s_sub_u32 s25, s11, s25
    s_and_b32 s26, s24, 3
    s_lshr_b32 s27, s24, 2
    s_cmp_ge_u32 s27, 14
    s_cselect_b32 s28, 1, 0
    s_mul_i32 s29, s28, 14
    s_sub_u32 s27, s27, s29
    s_lshl_b32 s29, s27, 2
    s_add_u32 s29, s29, s26
    s_mul_i32 s29, s29, 28672
    s_lshl_b32 s32, s25, 9
    s_add_u32 s34, s29, s32
    s_mul_i32 s29, s25, 458752
    s_lshl_b32 s32, s27, 12
    s_add_u32 s29, s29, s32
    s_lshl_b32 s32, s28, 10
    s_add_u32 s29, s29, s32
    s_lshr_b32 s32, s26, 1
    s_lshl_b32 s32, s32, 11
    s_add_u32 s29, s29, s32
    s_and_b32 s32, s26, 1
    s_lshl_b32 s32, s32, 9
    s_add_u32 s35, s29, s32
    s_waitcnt lgkmcnt(0)
    ds_read_b128 v[64:67], v7 offset:0
    ds_read_b128 v[68:71], v7 offset:128
    ds_read_b128 v[72:75], v7 offset:256
    ds_read_b128 v[76:79], v7 offset:384
    s_waitcnt lgkmcnt(3)
    buffer_store_dwordx4 v[64:67], v5, s[20:23], s35 offen offset:0 sc1
    s_waitcnt lgkmcnt(2)
    buffer_store_dwordx4 v[68:71], v5, s[20:23], s35 offen offset:128 sc1
    s_waitcnt lgkmcnt(1)
    buffer_store_dwordx4 v[72:75], v5, s[20:23], s35 offen offset:256 sc1
    s_waitcnt lgkmcnt(0)
    buffer_store_dwordx4 v[76:79], v5, s[20:23], s35 offen offset:384 sc1
    v_accvgpr_read_b32 v16, a16
    v_accvgpr_read_b32 v17, a17
    v_accvgpr_read_b32 v18, a18
    v_accvgpr_read_b32 v19, a19
    v_accvgpr_read_b32 v20, a20
    v_accvgpr_read_b32 v21, a21
    v_accvgpr_read_b32 v22, a22
    v_accvgpr_read_b32 v23, a23
    v_accvgpr_read_b32 v24, a24
    v_accvgpr_read_b32 v25, a25
    v_accvgpr_read_b32 v26, a26
    v_accvgpr_read_b32 v27, a27
    v_accvgpr_read_b32 v28, a28
    v_accvgpr_read_b32 v29, a29
    v_accvgpr_read_b32 v30, a30
    v_accvgpr_read_b32 v31, a31
    v_perm_b32 v32, v18, v16, s30
    v_perm_b32 v33, v22, v20, s30
    v_perm_b32 v34, v26, v24, s30
    v_perm_b32 v35, v30, v28, s30
    ds_write_b128 v4, v[32:35] offset:4096
    v_perm_b32 v36, v18, v16, s31
    v_perm_b32 v37, v22, v20, s31
    v_perm_b32 v38, v26, v24, s31
    v_perm_b32 v39, v30, v28, s31
    ds_write_b128 v4, v[36:39] offset:4112
    v_perm_b32 v40, v19, v17, s30
    v_perm_b32 v41, v23, v21, s30
    v_perm_b32 v42, v27, v25, s30
    v_perm_b32 v43, v31, v29, s30
    ds_write_b128 v4, v[40:43] offset:4128
    v_perm_b32 v44, v19, v17, s31
    v_perm_b32 v45, v23, v21, s31
    v_perm_b32 v46, v27, v25, s31
    v_perm_b32 v47, v31, v29, s31
    ds_write_b128 v4, v[44:47] offset:4144
    s_sub_u32 s11, s2, 120
    s_lshl_b32 s11, s11, 2
    s_add_u32 s11, s11, s3
    s_add_u32 s11, s11, 392
    s_mul_hi_u32 s24, s11, 613566757
    s_mul_i32 s25, s24, 7
    s_sub_u32 s25, s11, s25
    s_and_b32 s26, s24, 3
    s_lshr_b32 s27, s24, 2
    s_cmp_ge_u32 s27, 14
    s_cselect_b32 s28, 1, 0
    s_mul_i32 s29, s28, 14
    s_sub_u32 s27, s27, s29
    s_lshl_b32 s29, s27, 2
    s_add_u32 s29, s29, s26
    s_mul_i32 s29, s29, 28672
    s_lshl_b32 s32, s25, 9
    s_add_u32 s34, s29, s32
    s_mul_i32 s29, s25, 458752
    s_lshl_b32 s32, s27, 12
    s_add_u32 s29, s29, s32
    s_lshl_b32 s32, s28, 10
    s_add_u32 s29, s29, s32
    s_lshr_b32 s32, s26, 1
    s_lshl_b32 s32, s32, 11
    s_add_u32 s29, s29, s32
    s_and_b32 s32, s26, 1
    s_lshl_b32 s32, s32, 9
    s_add_u32 s35, s29, s32
    s_waitcnt lgkmcnt(0)
    ds_read_b128 v[200:203], v7 offset:4096
    ds_read_b128 v[204:207], v7 offset:4224
    ds_read_b128 v[208:211], v7 offset:4352
    ds_read_b128 v[212:215], v7 offset:4480
    s_waitcnt lgkmcnt(3)
    buffer_store_dwordx4 v[200:203], v5, s[20:23], s35 offen offset:0 sc1
    s_waitcnt lgkmcnt(2)
    buffer_store_dwordx4 v[204:207], v5, s[20:23], s35 offen offset:128 sc1
    s_waitcnt lgkmcnt(1)
    buffer_store_dwordx4 v[208:211], v5, s[20:23], s35 offen offset:256 sc1
    s_waitcnt lgkmcnt(0)
    buffer_store_dwordx4 v[212:215], v5, s[20:23], s35 offen offset:384 sc1
    s_branch RL_PUB
RL_SD:
    s_add_u32 s20, s6, 12582912
    s_addc_u32 s21, s7, 0
    s_mov_b32 s22, 1605632
    s_mov_b32 s23, 0x00020000
    v_lshrrev_b32 v4, 2, v1
    v_lshlrev_b32 v4, 9, v4
    v_and_b32 v6, 3, v1
    v_lshl_add_u32 v4, v6, 6, v4
    v_add_u32 v4, s33, v4
    v_lshlrev_b32 v7, 4, v1
    v_add_u32 v7, s33, v7
    v_lshrrev_b32 v5, 4, v1
    v_lshlrev_b32 v5, 10, v5
    v_lshl_add_u32 v5, v2, 4, v5
    s_sub_u32 s10, s2, 218
    s_lshl_b32 s10, s10, 2
    s_add_u32 s10, s10, s3
    s_lshr_b32 s25, s10, 2
    s_lshl_b32 s25, s25, 12
    s_and_b32 s26, s10, 3
    s_lshl_b32 s26, s26, 8
    s_add_u32 s25, s25, s26
    s_waitcnt vmcnt(0)
    v_accvgpr_read_b32 v16, a0
    v_accvgpr_read_b32 v17, a1
    v_accvgpr_read_b32 v18, a2
    v_accvgpr_read_b32 v19, a3
    v_accvgpr_read_b32 v20, a4
    v_accvgpr_read_b32 v21, a5
    v_accvgpr_read_b32 v22, a6
    v_accvgpr_read_b32 v23, a7
    v_accvgpr_read_b32 v24, a8
    v_accvgpr_read_b32 v25, a9
    v_accvgpr_read_b32 v26, a10
    v_accvgpr_read_b32 v27, a11
    v_accvgpr_read_b32 v28, a12
    v_accvgpr_read_b32 v29, a13
    v_accvgpr_read_b32 v30, a14
    v_accvgpr_read_b32 v31, a15
    v_accvgpr_read_b32 v32, a16
    v_accvgpr_read_b32 v33, a17
    v_accvgpr_read_b32 v34, a18
    v_accvgpr_read_b32 v35, a19
    v_accvgpr_read_b32 v36, a20
    v_accvgpr_read_b32 v37, a21
    v_accvgpr_read_b32 v38, a22
    v_accvgpr_read_b32 v39, a23
    v_accvgpr_read_b32 v40, a24
    v_accvgpr_read_b32 v41, a25
    v_accvgpr_read_b32 v42, a26
    v_accvgpr_read_b32 v43, a27
    v_accvgpr_read_b32 v44, a28
    v_accvgpr_read_b32 v45, a29
    v_accvgpr_read_b32 v46, a30
    v_accvgpr_read_b32 v47, a31
    v_perm_b32 v200, v20, v16, s30
    v_perm_b32 v201, v28, v24, s30
    v_perm_b32 v202, v36, v32, s30
    v_perm_b32 v203, v44, v40, s30
    ds_write_b128 v4, v[200:203] offset:0
    v_perm_b32 v204, v20, v16, s31
    v_perm_b32 v205, v28, v24, s31
    v_perm_b32 v206, v36, v32, s31
    v_perm_b32 v207, v44, v40, s31
    ds_write_b128 v4, v[204:207] offset:16
    v_perm_b32 v208, v21, v17, s30
    v_perm_b32 v209, v29, v25, s30
    v_perm_b32 v210, v37, v33, s30
    v_perm_b32 v211, v45, v41, s30
    ds_write_b128 v4, v[208:211] offset:32
    v_perm_b32 v212, v21, v17, s31
    v_perm_b32 v213, v29, v25, s31
    v_perm_b32 v214, v37, v33, s31
    v_perm_b32 v215, v45, v41, s31
    ds_write_b128 v4, v[212:215] offset:48
    v_perm_b32 v216, v22, v18, s30
    v_perm_b32 v217, v30, v26, s30
    v_perm_b32 v218, v38, v34, s30
    v_perm_b32 v219, v46, v42, s30
    ds_write_b128 v4, v[216:219] offset:256
    v_perm_b32 v220, v22, v18, s31
    v_perm_b32 v221, v30, v26, s31
    v_perm_b32 v222, v38, v34, s31
    v_perm_b32 v223, v46, v42, s31
    ds_write_b128 v4, v[220:223] offset:272
    v_perm_b32 v224, v23, v19, s30
    v_perm_b32 v225, v31, v27, s30
    v_perm_b32 v226, v39, v35, s30
    v_perm_b32 v227, v47, v43, s30
    ds_write_b128 v4, v[224:227] offset:288
    v_perm_b32 v228, v23, v19, s31
    v_perm_b32 v229, v31, v27, s31
    v_perm_b32 v230, v39, v35, s31
    v_perm_b32 v231, v47, v43, s31
    ds_write_b128 v4, v[228:231] offset:304
    s_waitcnt lgkmcnt(0)
    ds_read_b128 v[200:203], v7 offset:0
    ds_read_b128 v[204:207], v7 offset:1024
    ds_read_b128 v[208:211], v7 offset:2048
    ds_read_b128 v[212:215], v7 offset:3072
    ds_read_b128 v[216:219], v7 offset:4096
    ds_read_b128 v[220:223], v7 offset:5120
    ds_read_b128 v[224:227], v7 offset:6144
    s_waitcnt lgkmcnt(6)
    s_add_u32 s26, s25, 0
    buffer_store_dwordx4 v[200:203], v5, s[20:23], s26 offen sc1
    s_waitcnt lgkmcnt(5)
    s_add_u32 s26, s25, 229376
    buffer_store_dwordx4 v[204:207], v5, s[20:23], s26 offen sc1
    s_waitcnt lgkmcnt(4)
    s_add_u32 s26, s25, 458752
    buffer_store_dwordx4 v[208:211], v5, s[20:23], s26 offen sc1
    s_waitcnt lgkmcnt(3)
    s_add_u32 s26, s25, 688128
    buffer_store_dwordx4 v[212:215], v5, s[20:23], s26 offen sc1
    s_waitcnt lgkmcnt(2)
    s_add_u32 s26, s25, 917504
    buffer_store_dwordx4 v[216:219], v5, s[20:23], s26 offen sc1
    s_waitcnt lgkmcnt(1)
    s_add_u32 s26, s25, 1146880
    buffer_store_dwordx4 v[220:223], v5, s[20:23], s26 offen sc1
    s_waitcnt lgkmcnt(0)
    s_add_u32 s26, s25, 1376256
    buffer_store_dwordx4 v[224:227], v5, s[20:23], s26 offen sc1
    v_accvgpr_read_b32 v16, a32
    v_accvgpr_read_b32 v17, a33
    v_accvgpr_read_b32 v18, a34
    v_accvgpr_read_b32 v19, a35
    v_accvgpr_read_b32 v20, a36
    v_accvgpr_read_b32 v21, a37
    v_accvgpr_read_b32 v22, a38
    v_accvgpr_read_b32 v23, a39
    v_accvgpr_read_b32 v24, a40
    v_accvgpr_read_b32 v25, a41
    v_accvgpr_read_b32 v26, a42
    v_accvgpr_read_b32 v27, a43
    v_accvgpr_read_b32 v28, a44
    v_accvgpr_read_b32 v29, a45
    v_accvgpr_read_b32 v30, a46
    v_accvgpr_read_b32 v31, a47
    v_accvgpr_read_b32 v32, a48
    v_accvgpr_read_b32 v33, a49
    v_accvgpr_read_b32 v34, a50
    v_accvgpr_read_b32 v35, a51
    v_accvgpr_read_b32 v36, a52
    v_accvgpr_read_b32 v37, a53
    v_accvgpr_read_b32 v38, a54
    v_accvgpr_read_b32 v39, a55
    v_accvgpr_read_b32 v40, a56
    v_accvgpr_read_b32 v41, a57
    v_accvgpr_read_b32 v42, a58
    v_accvgpr_read_b32 v43, a59
    v_accvgpr_read_b32 v44, a60
    v_accvgpr_read_b32 v45, a61
    v_accvgpr_read_b32 v46, a62
    v_accvgpr_read_b32 v47, a63
    v_perm_b32 v200, v20, v16, s30
    v_perm_b32 v201, v28, v24, s30
    v_perm_b32 v202, v36, v32, s30
    v_perm_b32 v203, v44, v40, s30
    ds_write_b128 v4, v[200:203] offset:0
    v_perm_b32 v204, v20, v16, s31
    v_perm_b32 v205, v28, v24, s31
    v_perm_b32 v206, v36, v32, s31
    v_perm_b32 v207, v44, v40, s31
    ds_write_b128 v4, v[204:207] offset:16
    v_perm_b32 v208, v21, v17, s30
    v_perm_b32 v209, v29, v25, s30
    v_perm_b32 v210, v37, v33, s30
    v_perm_b32 v211, v45, v41, s30
    ds_write_b128 v4, v[208:211] offset:32
    v_perm_b32 v212, v21, v17, s31
    v_perm_b32 v213, v29, v25, s31
    v_perm_b32 v214, v37, v33, s31
    v_perm_b32 v215, v45, v41, s31
    ds_write_b128 v4, v[212:215] offset:48
    v_perm_b32 v216, v22, v18, s30
    v_perm_b32 v217, v30, v26, s30
    v_perm_b32 v218, v38, v34, s30
    v_perm_b32 v219, v46, v42, s30
    ds_write_b128 v4, v[216:219] offset:256
    v_perm_b32 v220, v22, v18, s31
    v_perm_b32 v221, v30, v26, s31
    v_perm_b32 v222, v38, v34, s31
    v_perm_b32 v223, v46, v42, s31
    ds_write_b128 v4, v[220:223] offset:272
    v_perm_b32 v224, v23, v19, s30
    v_perm_b32 v225, v31, v27, s30
    v_perm_b32 v226, v39, v35, s30
    v_perm_b32 v227, v47, v43, s30
    ds_write_b128 v4, v[224:227] offset:288
    v_perm_b32 v228, v23, v19, s31
    v_perm_b32 v229, v31, v27, s31
    v_perm_b32 v230, v39, v35, s31
    v_perm_b32 v231, v47, v43, s31
    ds_write_b128 v4, v[228:231] offset:304
    s_waitcnt lgkmcnt(0)
    ds_read_b128 v[200:203], v7 offset:0
    ds_read_b128 v[204:207], v7 offset:1024
    ds_read_b128 v[208:211], v7 offset:2048
    ds_read_b128 v[212:215], v7 offset:3072
    ds_read_b128 v[216:219], v7 offset:4096
    ds_read_b128 v[220:223], v7 offset:5120
    ds_read_b128 v[224:227], v7 offset:6144
    s_waitcnt lgkmcnt(6)
    s_add_u32 s26, s25, 114688
    buffer_store_dwordx4 v[200:203], v5, s[20:23], s26 offen sc1
    s_waitcnt lgkmcnt(5)
    s_add_u32 s26, s25, 344064
    buffer_store_dwordx4 v[204:207], v5, s[20:23], s26 offen sc1
    s_waitcnt lgkmcnt(4)
    s_add_u32 s26, s25, 573440
    buffer_store_dwordx4 v[208:211], v5, s[20:23], s26 offen sc1
    s_waitcnt lgkmcnt(3)
    s_add_u32 s26, s25, 802816
    buffer_store_dwordx4 v[212:215], v5, s[20:23], s26 offen sc1
    s_waitcnt lgkmcnt(2)
    s_add_u32 s26, s25, 1032192
    buffer_store_dwordx4 v[216:219], v5, s[20:23], s26 offen sc1
    s_waitcnt lgkmcnt(1)
    s_add_u32 s26, s25, 1261568
    buffer_store_dwordx4 v[220:223], v5, s[20:23], s26 offen sc1
    s_waitcnt lgkmcnt(0)
    s_add_u32 s26, s25, 1490944
    buffer_store_dwordx4 v[224:227], v5, s[20:23], s26 offen sc1
RL_PUB:
    s_waitcnt vmcnt(0)
    s_barrier
    s_cmp_ge_u32 s2, 218
    s_cbranch_scc1 RL_WDF
    s_cmp_lg_u32 s3, 0
    s_cbranch_scc1 EWF_NF
    s_and_b32 s34, s2, 15
    s_lshl_b32 s34, s34, 7
    s_lshr_b32 s35, s2, 4
    s_lshl_b32 s35, s35, 2
    s_add_u32 s34, s34, s35
    s_add_u32 s34, s34, 24576
    v_mov_b32 v12, s96
    v_lshlrev_b32 v13, 11, v1
    v_cmp_gt_u32 vcc, 8, v1
    v_mov_b32 v11, 0x7ff00000
    s_nop 0
    v_cndmask_b32 v13, v11, v13, vcc
    buffer_store_dword v12, v13, s[52:55], s34 offen sc1
EWF_NF:
    s_branch RL_WDX
RL_WDF:
    s_cmp_lg_u32 s3, 0
    s_cbranch_scc1 RL_WDX
    s_sub_u32 s34, s2, 218
    s_lshl_b32 s34, s34, 2
    s_add_u32 s34, s34, 6144
    v_mov_b32 v12, s96
    v_mov_b32 v13, 0
    buffer_store_dword v12, v13, s[52:55], s34 offen sc1
RL_WDX:
RL_RET:
    s_bfe_u32 s58, s2, 0x20001
    s_lshl_b32 s58, s58, 2
    s_bfe_u32 s59, s2, 0x20003
    s_add_u32 s58, s58, s59
    s_and_b32 s59, s2, 1
    s_mul_i32 s59, s59, 7
    s_lshr_b32 s60, s2, 5
    s_add_u32 s59, s59, s60
    s_lshl_b32 s60, s59, 2
    s_add_u32 s60, s60, s3
    s_mul_i32 s61, s60, 57344
    s_add_u32 s36, s6, 8388608
    s_addc_u32 s37, s7, 0
    s_mov_b32 s38, 3211264
    s_mov_b32 s39, 0x00020000
    s_cmp_lt_u32 s2, 224
    s_cselect_b32 s38, 3211264, 0
    v_lshlrev_b32 v250, 4, v1
    s_lshr_b32 s11, s2, 5
    s_lshl_b32 s11, s11, 3
    s_and_b32 s9, s2, 7
    s_add_u32 s11, s11, s9
    s_bfe_u32 s10, s2, 0x10003
    s_bfe_u32 s9, s2, 0x10004
    s_lshl_b32 s8, s9, 2
    s_add_u32 s8, s8, s3
    s_mul_i32 s28, s11, 30720
    s_lshl_b32 s29, s3, 12
    s_add_u32 s28, s28, s29
    s_add_u32 s29, s28, 16384
    v_mul_u32_u24 v5, 57344, v2
    v_lshl_add_u32 v5, v3, 4, v5
    s_mul_i32 s30, s10, 917504
    s_mul_i32 s31, s11, 896
    s_add_u32 s30, s30, s31
    s_lshl_b32 s31, s8, 6
    s_add_u32 s30, s30, s31
    s_add_u32 s12, s6, 2097152
    s_addc_u32 s13, s7, 0
    s_mov_b32 s14, 1966080
    s_mov_b32 s15, 0x00020000
    s_mov_b32 s16, s4
    s_mov_b32 s17, s5
    s_mov_b32 s18, 1835008
    s_mov_b32 s19, 0x00020000
    s_add_u32 s20, s6, 4194304
    s_addc_u32 s21, s7, 0
    s_mov_b32 s22, 1835008
    s_mov_b32 s23, 0x00020000
    s_add_u32 s24, s6, 14680064
    s_addc_u32 s25, s7, 0
    s_mov_b32 s26, 131072
    s_mov_b32 s27, 0x00020000
    s_add_u32 s44, s6, 15204352
    s_addc_u32 s45, s7, 0
    s_mov_b32 s46, 8192
    s_mov_b32 s47, 0x00020000
    s_add_u32 s48, s6, 25165824
    s_addc_u32 s49, s7, 0
    s_mov_b32 s50, 1835008
    s_mov_b32 s51, 0x00020000
    s_lshl_b32 s34, s11, 1
    s_add_u32 s34, s34, s10
    s_lshl_b32 s34, s34, 6
    v_lshlrev_b32 v238, 2, v2
    buffer_load_dwordx4 v[240:243], v5, s[16:19], s30 offen
    buffer_load_dwordx4 v[244:247], v5, s[16:19], s30 offen offset:448
    v_lshlrev_b32 v14, 4, v1
    s_lshl_b32 s32, s3, 10
    v_add_u32 v15, s32, v14
    s_waitcnt lgkmcnt(0)
    s_cmp_lg_u32 s3, 0
    s_cbranch_scc1 EW_DONE
    v_lshrrev_b32 v16, 2, v1
    v_lshlrev_b32 v16, 7, v16
    v_and_b32 v17, 3, v1
    v_lshl_add_u32 v16, v17, 4, v16
    s_and_b32 s62, s2, 7
    s_lshl_b32 s62, s62, 11
    s_add_u32 s62, s62, 24576
    s_mov_b32 s63, 0
EW_LOOP:
    buffer_load_dwordx4 v[20:23], v16, s[52:55], s62 offen sc1
    s_add_u32 s63, s63, 1
    s_waitcnt vmcnt(0)
    v_xor_b32 v20, s96, v20
    v_xor_b32 v21, s96, v21
    v_xor_b32 v22, s96, v22
    v_xor_b32 v23, s96, v23
    v_or_b32 v20, v20, v21
    v_or3_b32 v20, v20, v22, v23
    v_cmp_ne_u32 vcc, 0, v20
    s_nop 4
    s_cmp_eq_u64 vcc, 0
    s_cbranch_scc1 EW_DONE
    s_sleep 2
    s_cmp_lt_u32 s63, 0x40000
    s_cbranch_scc1 EW_LOOP
EW_DONE:
    s_barrier
    s_cmp_lt_u32 s2, 120
    s_cbranch_scc1 EW_SKIP
    s_cmp_eq_u32 s3, 0
    s_cbranch_scc1 EW_SKIP
    s_add_u32 s40, s61, 0
    buffer_load_dwordx4 a[0:3], v250, s[36:39], s40 offen offset:0 sc1
    buffer_load_dwordx4 a[4:7], v250, s[36:39], s40 offen offset:1024 sc1
    buffer_load_dwordx4 a[8:11], v250, s[36:39], s40 offen offset:2048 sc1
    buffer_load_dwordx4 a[12:15], v250, s[36:39], s40 offen offset:3072 sc1
    s_add_u32 s40, s61, 4096
    buffer_load_dwordx4 a[16:19], v250, s[36:39], s40 offen offset:0 sc1
    buffer_load_dwordx4 a[20:23], v250, s[36:39], s40 offen offset:1024 sc1
    buffer_load_dwordx4 a[24:27], v250, s[36:39], s40 offen offset:2048 sc1
    buffer_load_dwordx4 a[28:31], v250, s[36:39], s40 offen offset:3072 sc1
    s_add_u32 s40, s61, 8192
    buffer_load_dwordx4 a[32:35], v250, s[36:39], s40 offen offset:0 sc1
    buffer_load_dwordx4 a[36:39], v250, s[36:39], s40 offen offset:1024 sc1
    buffer_load_dwordx4 a[40:43], v250, s[36:39], s40 offen offset:2048 sc1
    buffer_load_dwordx4 a[44:47], v250, s[36:39], s40 offen offset:3072 sc1
    s_add_u32 s40, s61, 12288
    buffer_load_dwordx4 a[48:51], v250, s[36:39], s40 offen offset:0 sc1
    buffer_load_dwordx4 a[52:55], v250, s[36:39], s40 offen offset:1024 sc1
    buffer_load_dwordx4 a[56:59], v250, s[36:39], s40 offen offset:2048 sc1
    buffer_load_dwordx4 a[60:63], v250, s[36:39], s40 offen offset:3072 sc1
    s_add_u32 s40, s61, 16384
    buffer_load_dwordx4 a[64:67], v250, s[36:39], s40 offen offset:0 sc1
    buffer_load_dwordx4 a[68:71], v250, s[36:39], s40 offen offset:1024 sc1
    buffer_load_dwordx4 a[72:75], v250, s[36:39], s40 offen offset:2048 sc1
    buffer_load_dwordx4 a[76:79], v250, s[36:39], s40 offen offset:3072 sc1
    s_add_u32 s40, s61, 20480
    buffer_load_dwordx4 a[80:83], v250, s[36:39], s40 offen offset:0 sc1
    buffer_load_dwordx4 a[84:87], v250, s[36:39], s40 offen offset:1024 sc1
    buffer_load_dwordx4 a[88:91], v250, s[36:39], s40 offen offset:2048 sc1
    buffer_load_dwordx4 a[92:95], v250, s[36:39], s40 offen offset:3072 sc1
    s_add_u32 s40, s61, 24576
    buffer_load_dwordx4 a[96:99], v250, s[36:39], s40 offen offset:0 sc1
    buffer_load_dwordx4 a[100:103], v250, s[36:39], s40 offen offset:1024 sc1
    buffer_load_dwordx4 a[104:107], v250, s[36:39], s40 offen offset:2048 sc1
    buffer_load_dwordx4 a[108:111], v250, s[36:39], s40 offen offset:3072 sc1
EW_SKIP:
    s_cmp_lg_u32 s3, 0
    s_cbranch_scc1 E2_DONE
    v_lshrrev_b32 v16, 2, v1
    v_lshlrev_b32 v16, 7, v16
    v_and_b32 v17, 3, v1
    v_lshl_add_u32 v16, v17, 4, v16
    s_and_b32 s62, s2, 7
    s_lshl_b32 s62, s62, 11
    s_add_u32 s62, s62, 8192
    s_mov_b32 s63, 0
E2_LOOP:
    buffer_load_dwordx4 v[20:23], v16, s[52:55], s62 offen sc1
    s_add_u32 s63, s63, 1
    s_waitcnt vmcnt(0)
    v_xor_b32 v20, s96, v20
    v_xor_b32 v21, s96, v21
    v_xor_b32 v22, s96, v22
    v_xor_b32 v23, s96, v23
    v_or_b32 v20, v20, v21
    v_or3_b32 v20, v20, v22, v23
    v_cmp_ne_u32 vcc, 0, v20
    s_nop 4
    s_cmp_eq_u64 vcc, 0
    s_cbranch_scc1 E2_DONE
    s_sleep 2
    s_cmp_lt_u32 s63, 0x40000
    s_cbranch_scc1 E2_LOOP
E2_DONE:
    s_barrier
    buffer_load_dwordx4 v[16:19], v250, s[12:15], s28 offen offset:0 sc1
    buffer_load_dwordx4 v[20:23], v250, s[12:15], s28 offen offset:1024 sc1
    buffer_load_dwordx4 v[24:27], v250, s[12:15], s28 offen offset:2048 sc1
    buffer_load_dwordx4 v[28:31], v250, s[12:15], s28 offen offset:3072 sc1
    buffer_load_dwordx4 v[32:35], v250, s[12:15], s29 offen offset:0 sc1
    buffer_load_dwordx4 v[36:39], v250, s[12:15], s29 offen offset:1024 sc1
    buffer_load_dwordx4 v[40:43], v250, s[12:15], s29 offen offset:2048 sc1
    buffer_load_dwordx4 v[44:47], v250, s[12:15], s29 offen offset:3072 sc1
    buffer_load_dword v239, v238, s[44:47], s34 offen sc1
    s_waitcnt vmcnt(5)
    v_mfma_f32_16x16x32_bf16 v[200:203], v[16:19], v[48:51], 0
    v_mfma_f32_16x16x32_bf16 v[204:207], v[16:19], v[56:59], 0
    v_mfma_f32_16x16x32_bf16 v[208:211], v[24:27], v[48:51], 0
    v_mfma_f32_16x16x32_bf16 v[212:215], v[24:27], v[56:59], 0
    v_mfma_f32_16x16x32_bf16 v[200:203], v[20:23], v[52:55], v[200:203]
    v_mfma_f32_16x16x32_bf16 v[204:207], v[20:23], v[60:63], v[204:207]
    v_mfma_f32_16x16x32_bf16 v[208:211], v[28:31], v[52:55], v[208:211]
    v_mfma_f32_16x16x32_bf16 v[212:215], v[28:31], v[60:63], v[212:215]
    s_waitcnt vmcnt(0)
    v_mfma_f32_16x16x32_bf16 v[216:219], v[32:35], v[48:51], 0
    v_mfma_f32_16x16x32_bf16 v[220:223], v[32:35], v[56:59], 0
    v_mfma_f32_16x16x32_bf16 v[224:227], v[40:43], v[48:51], 0
    v_mfma_f32_16x16x32_bf16 v[228:231], v[40:43], v[56:59], 0
    v_mfma_f32_16x16x32_bf16 v[216:219], v[36:39], v[52:55], v[216:219]
    v_mfma_f32_16x16x32_bf16 v[220:223], v[36:39], v[60:63], v[220:223]
    v_mfma_f32_16x16x32_bf16 v[224:227], v[44:47], v[52:55], v[224:227]
    v_mfma_f32_16x16x32_bf16 v[228:231], v[44:47], v[60:63], v[228:231]
    v_cvt_pk_bf16_f32 v64, v200, v204
    v_cvt_pk_bf16_f32 v68, v201, v205
    v_cvt_pk_bf16_f32 v65, v202, v206
    v_cvt_pk_bf16_f32 v69, v203, v207
    v_cvt_pk_bf16_f32 v66, v208, v212
    v_cvt_pk_bf16_f32 v70, v209, v213
    v_cvt_pk_bf16_f32 v67, v210, v214
    v_cvt_pk_bf16_f32 v71, v211, v215
    ds_write_b128 v15, v[64:67] offset:0
    ds_write_b128 v15, v[68:71] offset:8192
    v_cvt_pk_bf16_f32 v72, v216, v220
    v_cvt_pk_bf16_f32 v76, v217, v221
    v_cvt_pk_bf16_f32 v73, v218, v222
    v_cvt_pk_bf16_f32 v77, v219, v223
    v_cvt_pk_bf16_f32 v74, v224, v228
    v_cvt_pk_bf16_f32 v78, v225, v229
    v_cvt_pk_bf16_f32 v75, v226, v230
    v_cvt_pk_bf16_f32 v79, v227, v231
    ds_write_b128 v15, v[72:75] offset:4096
    ds_write_b128 v15, v[76:79] offset:12288
    s_lshl_b32 s29, s11, 1
    s_add_u32 s29, s29, s10
    s_lshl_b32 s32, s29, 10
    s_lshl_b32 s33, s8, 3
    s_add_u32 s32, s32, s33
    s_mul_i32 s29, s29, 14
    s_add_u32 s29, s29, s8
    s_lshl_b32 s29, s29, 10
    s_add_u32 s31, s29, 7168
    v_lshlrev_b32 v6, 6, v2
    s_waitcnt lgkmcnt(0)
    s_barrier
    v_mov_b32 v10, 0
    v_mov_b32 v11, 0
    s_cmp_eq_u32 s8, 7
    s_cbranch_scc1 K3_PUB
    v_lshlrev_b32 v238, 4, v2
    ds_read_u16 v238, v238
    ds_read_b128 v[16:19], v14 offset:0
    ds_read_b128 v[20:23], v14 offset:1024
    ds_read_b128 v[24:27], v14 offset:2048
    ds_read_b128 v[28:31], v14 offset:3072
    ds_read_b128 v[32:35], v14 offset:4096
    ds_read_b128 v[36:39], v14 offset:5120
    s_waitcnt lgkmcnt(5)
    v_mfma_f32_16x16x32_bf16 v[64:67], v[80:83], v[16:19], 0
    v_mfma_f32_16x16x32_bf16 v[68:71], v[140:143], v[16:19], 0
    ds_read_b128 v[16:19], v14 offset:6144
    s_waitcnt lgkmcnt(5)
    v_mfma_f32_16x16x32_bf16 v[64:67], v[84:87], v[20:23], v[64:67]
    v_mfma_f32_16x16x32_bf16 v[68:71], v[144:147], v[20:23], v[68:71]
    ds_read_b128 v[20:23], v14 offset:7168
    s_waitcnt lgkmcnt(5)
    v_mfma_f32_16x16x32_bf16 v[64:67], v[88:91], v[24:27], v[64:67]
    v_mfma_f32_16x16x32_bf16 v[68:71], v[148:151], v[24:27], v[68:71]
    ds_read_b128 v[24:27], v14 offset:8192
    s_waitcnt lgkmcnt(5)
    v_mfma_f32_16x16x32_bf16 v[64:67], v[92:95], v[28:31], v[64:67]
    v_mfma_f32_16x16x32_bf16 v[68:71], v[152:155], v[28:31], v[68:71]
    ds_read_b128 v[28:31], v14 offset:9216
    s_waitcnt lgkmcnt(5)
    v_mfma_f32_16x16x32_bf16 v[64:67], v[96:99], v[32:35], v[64:67]
    v_mfma_f32_16x16x32_bf16 v[68:71], v[156:159], v[32:35], v[68:71]
    ds_read_b128 v[32:35], v14 offset:10240
    s_waitcnt lgkmcnt(5)
    v_mfma_f32_16x16x32_bf16 v[64:67], v[100:103], v[36:39], v[64:67]
    v_mfma_f32_16x16x32_bf16 v[68:71], v[160:163], v[36:39], v[68:71]
    ds_read_b128 v[36:39], v14 offset:11264
    s_waitcnt lgkmcnt(5)
    v_mfma_f32_16x16x32_bf16 v[64:67], v[104:107], v[16:19], v[64:67]
    v_mfma_f32_16x16x32_bf16 v[68:71], v[164:167], v[16:19], v[68:71]
    ds_read_b128 v[16:19], v14 offset:12288
    s_waitcnt lgkmcnt(5)
    v_mfma_f32_16x16x32_bf16 v[64:67], v[108:111], v[20:23], v[64:67]
    v_mfma_f32_16x16x32_bf16 v[68:71], v[168:171], v[20:23], v[68:71]
    ds_read_b128 v[20:23], v14 offset:13312
    s_waitcnt lgkmcnt(5)
    v_mfma_f32_16x16x32_bf16 v[72:75], v[112:115], v[24:27], 0
    v_mfma_f32_16x16x32_bf16 v[76:79], v[172:175], v[24:27], 0
    ds_read_b128 v[24:27], v14 offset:14336
    v_lshlrev_b32 v200, 16, v240
    v_and_b32 v201, 0xffff0000, v240
    v_lshlrev_b32 v202, 16, v241
    v_and_b32 v203, 0xffff0000, v241
    v_lshlrev_b32 v204, 16, v242
    v_and_b32 v205, 0xffff0000, v242
    v_lshlrev_b32 v206, 16, v243
    v_and_b32 v207, 0xffff0000, v243
    v_lshlrev_b32 v208, 16, v244
    v_and_b32 v209, 0xffff0000, v244
    v_lshlrev_b32 v210, 16, v245
    v_and_b32 v211, 0xffff0000, v245
    v_lshlrev_b32 v212, 16, v246
    v_and_b32 v213, 0xffff0000, v246
    v_lshlrev_b32 v214, 16, v247
    v_and_b32 v215, 0xffff0000, v247
    v_lshlrev_b32 v238, 16, v238
    v_mul_f32 v238, 0.5, v238
    v_fmamk_f32 v238, v239, 0x3b124925, v238
    v_cvt_pk_bf16_f32 v238, v238, v238
    v_and_b32 v238, 0xffff0000, v238
    s_waitcnt lgkmcnt(5)
    v_mfma_f32_16x16x32_bf16 v[72:75], v[116:119], v[28:31], v[72:75]
    v_mfma_f32_16x16x32_bf16 v[76:79], v[176:179], v[28:31], v[76:79]
    s_waitcnt lgkmcnt(4)
    v_mfma_f32_16x16x32_bf16 v[72:75], v[120:123], v[32:35], v[72:75]
    v_mfma_f32_16x16x32_bf16 v[76:79], v[180:183], v[32:35], v[76:79]
    s_waitcnt lgkmcnt(3)
    v_mfma_f32_16x16x32_bf16 v[72:75], v[124:127], v[36:39], v[72:75]
    v_mfma_f32_16x16x32_bf16 v[76:79], v[184:187], v[36:39], v[76:79]
    s_waitcnt lgkmcnt(2)
    v_mfma_f32_16x16x32_bf16 v[72:75], v[128:131], v[16:19], v[72:75]
    v_mfma_f32_16x16x32_bf16 v[76:79], v[188:191], v[16:19], v[76:79]
    s_waitcnt lgkmcnt(1)
    v_mfma_f32_16x16x32_bf16 v[72:75], v[132:135], v[20:23], v[72:75]
    v_mfma_f32_16x16x32_bf16 v[76:79], v[192:195], v[20:23], v[76:79]
    s_waitcnt lgkmcnt(0)
    v_mfma_f32_16x16x32_bf16 v[72:75], v[136:139], v[24:27], v[72:75]
    v_mfma_f32_16x16x32_bf16 v[76:79], v[196:199], v[24:27], v[76:79]
    s_nop 6
    v_pk_add_f32 v[80:81], v[64:65], v[72:73]
    v_pk_add_f32 v[88:89], v[64:65], v[72:73] neg_lo:[0,1] neg_hi:[0,1]
    v_pk_add_f32 v[82:83], v[66:67], v[74:75]
    v_pk_add_f32 v[90:91], v[66:67], v[74:75] neg_lo:[0,1] neg_hi:[0,1]
    v_pk_add_f32 v[84:85], v[68:69], v[76:77]
    v_pk_add_f32 v[92:93], v[68:69], v[76:77] neg_lo:[0,1] neg_hi:[0,1]
    v_pk_add_f32 v[86:87], v[70:71], v[78:79]
    v_pk_add_f32 v[94:95], v[70:71], v[78:79] neg_lo:[0,1] neg_hi:[0,1]
    v_cvt_pk_bf16_f32 v120, v80, v81
    v_cvt_pk_bf16_f32 v121, v82, v83
    v_cvt_pk_bf16_f32 v122, v84, v85
    v_cvt_pk_bf16_f32 v123, v86, v87
    v_cvt_pk_bf16_f32 v124, v88, v89
    v_cvt_pk_bf16_f32 v125, v90, v91
    v_cvt_pk_bf16_f32 v126, v92, v93
    v_cvt_pk_bf16_f32 v127, v94, v95
    v_lshlrev_b32 v80, 16, v120
    v_and_b32 v81, 0xffff0000, v120
    v_lshlrev_b32 v82, 16, v121
    v_and_b32 v83, 0xffff0000, v121
    v_lshlrev_b32 v84, 16, v122
    v_and_b32 v85, 0xffff0000, v122
    v_lshlrev_b32 v86, 16, v123
    v_and_b32 v87, 0xffff0000, v123
    v_lshlrev_b32 v88, 16, v124
    v_and_b32 v89, 0xffff0000, v124
    v_lshlrev_b32 v90, 16, v125
    v_and_b32 v91, 0xffff0000, v125
    v_lshlrev_b32 v92, 16, v126
    v_and_b32 v93, 0xffff0000, v126
    v_lshlrev_b32 v94, 16, v127
    v_and_b32 v95, 0xffff0000, v127
    v_pk_add_f32 v[80:81], v[80:81], v[200:201]
    v_pk_add_f32 v[82:83], v[82:83], v[202:203]
    v_pk_add_f32 v[84:85], v[84:85], v[204:205]
    v_pk_add_f32 v[86:87], v[86:87], v[206:207]
    v_pk_add_f32 v[88:89], v[88:89], v[208:209]
    v_pk_add_f32 v[90:91], v[90:91], v[210:211]
    v_pk_add_f32 v[92:93], v[92:93], v[212:213]
    v_pk_add_f32 v[94:95], v[94:95], v[214:215]
    v_cvt_pk_bf16_f32 v112, v80, v81
    v_cvt_pk_bf16_f32 v113, v82, v83
    v_cvt_pk_bf16_f32 v114, v84, v85
    v_cvt_pk_bf16_f32 v115, v86, v87
    v_cvt_pk_bf16_f32 v116, v88, v89
    v_cvt_pk_bf16_f32 v117, v90, v91
    v_cvt_pk_bf16_f32 v118, v92, v93
    v_cvt_pk_bf16_f32 v119, v94, v95
    buffer_store_dwordx4 v[112:115], v14, s[20:23], s29 offen sc1
    buffer_store_dwordx4 v[116:119], v14, s[20:23], s31 offen sc1
    v_mov_b32 v8, 0x3f803f80
    v_lshlrev_b32 v80, 16, v112
    v_and_b32 v81, 0xffff0000, v112
    v_lshlrev_b32 v82, 16, v113
    v_and_b32 v83, 0xffff0000, v113
    v_lshlrev_b32 v84, 16, v114
    v_and_b32 v85, 0xffff0000, v114
    v_lshlrev_b32 v86, 16, v115
    v_and_b32 v87, 0xffff0000, v115
    v_lshlrev_b32 v88, 16, v116
    v_and_b32 v89, 0xffff0000, v116
    v_lshlrev_b32 v90, 16, v117
    v_and_b32 v91, 0xffff0000, v117
    v_lshlrev_b32 v92, 16, v118
    v_and_b32 v93, 0xffff0000, v118
    v_lshlrev_b32 v94, 16, v119
    v_and_b32 v95, 0xffff0000, v119
    v_sub_f32 v80, v80, v238
    v_sub_f32 v81, v81, v238
    v_sub_f32 v82, v82, v238
    v_sub_f32 v83, v83, v238
    v_sub_f32 v84, v84, v238
    v_sub_f32 v85, v85, v238
    v_sub_f32 v86, v86, v238
    v_sub_f32 v87, v87, v238
    v_sub_f32 v88, v88, v238
    v_sub_f32 v89, v89, v238
    v_sub_f32 v90, v90, v238
    v_sub_f32 v91, v91, v238
    v_sub_f32 v92, v92, v238
    v_sub_f32 v93, v93, v238
    v_sub_f32 v94, v94, v238
    v_sub_f32 v95, v95, v238
    v_cvt_pk_bf16_f32 v120, v80, v81
    v_cvt_pk_bf16_f32 v121, v82, v83
    v_cvt_pk_bf16_f32 v122, v84, v85
    v_cvt_pk_bf16_f32 v123, v86, v87
    v_cvt_pk_bf16_f32 v124, v88, v89
    v_cvt_pk_bf16_f32 v125, v90, v91
    v_cvt_pk_bf16_f32 v126, v92, v93
    v_cvt_pk_bf16_f32 v127, v94, v95
    buffer_store_dwordx4 v[120:123], v14, s[48:51], s29 offen sc1
    buffer_store_dwordx4 v[124:127], v14, s[48:51], s31 offen sc1
    v_dot2_f32_bf16 v10, v120, v8, 0
    v_dot2_f32_bf16 v11, v120, v120, 0
    v_dot2_f32_bf16 v12, v121, v8, 0
    v_dot2_f32_bf16 v13, v121, v121, 0
    v_dot2_f32_bf16 v10, v122, v8, v10
    v_dot2_f32_bf16 v11, v122, v122, v11
    v_dot2_f32_bf16 v12, v123, v8, v12
    v_dot2_f32_bf16 v13, v123, v123, v13
    v_dot2_f32_bf16 v10, v124, v8, v10
    v_dot2_f32_bf16 v11, v124, v124, v11
    v_dot2_f32_bf16 v12, v125, v8, v12
    v_dot2_f32_bf16 v13, v125, v125, v13
    v_dot2_f32_bf16 v10, v126, v8, v10
    v_dot2_f32_bf16 v11, v126, v126, v11
    v_dot2_f32_bf16 v12, v127, v8, v12
    v_dot2_f32_bf16 v13, v127, v127, v13
    s_nop 2
    v_pk_add_f32 v[10:11], v[10:11], v[12:13]
    v_mov_b32 v12, v10
    v_mov_b32 v13, v11
    s_nop 0
    v_permlane16_swap_b32 v10, v12
    v_permlane16_swap_b32 v11, v13
    v_add_f32 v10, v10, v12
    v_add_f32 v11, v11, v13
    v_mov_b32 v12, v10
    v_mov_b32 v13, v11
    s_nop 0
    v_permlane32_swap_b32 v10, v12
    v_permlane32_swap_b32 v11, v13
    v_add_f32 v10, v10, v12
    v_add_f32 v11, v11, v13
    s_nop 7
    s_nop 7
K3_PUB:
    buffer_store_dwordx2 v[10:11], v6, s[24:27], s32 offen sc1
    s_lshl_b32 s33, s11, 1
    s_add_u32 s33, s33, s10
    s_lshr_b32 s34, s33, 3
    s_lshl_b32 s34, s34, 7
    s_and_b32 s33, s33, 7
    s_lshl_b32 s33, s33, 1
    s_add_u32 s33, s33, s9
    s_lshl_b32 s33, s33, 2
    s_add_u32 s34, s34, s33
    v_mov_b32 v12, s96
    v_mov_b32 v13, 0
    s_waitcnt vmcnt(0)
    s_barrier
    s_cmp_lg_u32 s3, 0
    s_cbranch_scc1 K3_NOFLAG
    buffer_store_dword v12, v13, s[52:55], s34 offen sc1
K3_NOFLAG:
    s_cmp_lt_u32 s2, 120
    s_cselect_b32 s33, 0, s3
    s_cmp_lg_u32 s33, 0
    s_cbranch_scc1 WL_X
    s_add_u32 s40, s61, 0
    buffer_load_dwordx4 a[0:3], v250, s[36:39], s40 offen offset:0 sc1
    buffer_load_dwordx4 a[4:7], v250, s[36:39], s40 offen offset:1024 sc1
    buffer_load_dwordx4 a[8:11], v250, s[36:39], s40 offen offset:2048 sc1
    buffer_load_dwordx4 a[12:15], v250, s[36:39], s40 offen offset:3072 sc1
    s_add_u32 s40, s61, 4096
    buffer_load_dwordx4 a[16:19], v250, s[36:39], s40 offen offset:0 sc1
    buffer_load_dwordx4 a[20:23], v250, s[36:39], s40 offen offset:1024 sc1
    buffer_load_dwordx4 a[24:27], v250, s[36:39], s40 offen offset:2048 sc1
    buffer_load_dwordx4 a[28:31], v250, s[36:39], s40 offen offset:3072 sc1
    s_add_u32 s40, s61, 8192
    buffer_load_dwordx4 a[32:35], v250, s[36:39], s40 offen offset:0 sc1
    buffer_load_dwordx4 a[36:39], v250, s[36:39], s40 offen offset:1024 sc1
    buffer_load_dwordx4 a[40:43], v250, s[36:39], s40 offen offset:2048 sc1
    buffer_load_dwordx4 a[44:47], v250, s[36:39], s40 offen offset:3072 sc1
    s_add_u32 s40, s61, 12288
    buffer_load_dwordx4 a[48:51], v250, s[36:39], s40 offen offset:0 sc1
    buffer_load_dwordx4 a[52:55], v250, s[36:39], s40 offen offset:1024 sc1
    buffer_load_dwordx4 a[56:59], v250, s[36:39], s40 offen offset:2048 sc1
    buffer_load_dwordx4 a[60:63], v250, s[36:39], s40 offen offset:3072 sc1
    s_add_u32 s40, s61, 16384
    buffer_load_dwordx4 a[64:67], v250, s[36:39], s40 offen offset:0 sc1
    buffer_load_dwordx4 a[68:71], v250, s[36:39], s40 offen offset:1024 sc1
    buffer_load_dwordx4 a[72:75], v250, s[36:39], s40 offen offset:2048 sc1
    buffer_load_dwordx4 a[76:79], v250, s[36:39], s40 offen offset:3072 sc1
    s_add_u32 s40, s61, 20480
    buffer_load_dwordx4 a[80:83], v250, s[36:39], s40 offen offset:0 sc1
    buffer_load_dwordx4 a[84:87], v250, s[36:39], s40 offen offset:1024 sc1
    buffer_load_dwordx4 a[88:91], v250, s[36:39], s40 offen offset:2048 sc1
    buffer_load_dwordx4 a[92:95], v250, s[36:39], s40 offen offset:3072 sc1
    s_add_u32 s40, s61, 24576
    buffer_load_dwordx4 a[96:99], v250, s[36:39], s40 offen offset:0 sc1
    buffer_load_dwordx4 a[100:103], v250, s[36:39], s40 offen offset:1024 sc1
    buffer_load_dwordx4 a[104:107], v250, s[36:39], s40 offen offset:2048 sc1
    buffer_load_dwordx4 a[108:111], v250, s[36:39], s40 offen offset:3072 sc1
WL_X:
    s_cmp_ge_u32 s2, 224
    s_cbranch_scc1 K3_FIN
    v_lshlrev_b32 v4, 4, v1
    s_mul_i32 s25, s58, 114688
    s_mul_i32 s24, s3, 28672
    s_add_u32 s12, s6, 25165824
    s_addc_u32 s13, s7, 0
    s_mov_b32 s14, 1835008
    s_mov_b32 s15, 0x00020000
    s_add_u32 s40, s6, 14680064
    s_addc_u32 s41, s7, 0
    s_mov_b32 s42, 131072
    s_mov_b32 s43, 0x00020000
    s_add_u32 s20, s6, 16777216
    s_addc_u32 s21, s7, 0
    s_mov_b32 s22, 7340032
    s_mov_b32 s23, 0x00020000
    s_add_u32 s16, s6, 12582912
    s_addc_u32 s17, s7, 0
    s_mov_b32 s18, 1605632
    s_mov_b32 s19, 0x00020000
    v_bfe_u32 v7, v1, 4, 1
    v_lshrrev_b32 v8, 5, v1
    v_lshlrev_b32 v9, 4, v2
    v_lshl_add_u32 v9, v8, 8, v9
    v_mul_u32_u24 v5, 14336, v7
    v_add_u32 v5, v5, v9
    v_add_u32 v6, 57344, v5
    v_mul_u32_u24 v10, 57344, v7
    v_add_u32 v10, v10, v9
    s_lshl_b32 s29, s58, 13
    s_lshl_b32 s30, s3, 11
    s_add_u32 s29, s29, s30
    v_and_b32 v11, 31, v1
    v_lshlrev_b32 v11, 6, v11
    v_lshl_add_u32 v11, v8, 5, v11
    s_and_b32 s44, s2, 7
    s_lshl_b32 s44, s44, 2
    s_bfe_u32 s45, s2, 0x20003
    s_add_u32 s44, s44, s45
    s_lshr_b32 s45, s2, 5
    s_mul_i32 s46, s45, 56
    s_mul_i32 s47, s3, 14
    s_add_u32 s46, s46, s47
    s_lshl_b32 s46, s46, 12
    s_mul_i32 s31, s45, 2
    s_lshl_b32 s34, s58, 7
    s_cmp_lt_u32 s2, 120
    s_cselect_b32 s33, 0, s3
    s_cmp_eq_u32 s33, 0
    s_cbranch_scc1 E3_W0
    s_add_u32 s28, s61, 28672
    buffer_load_dwordx4 a[112:115], v4, s[36:39], s28 offen offset:0 sc1
    buffer_load_dwordx4 a[116:119], v4, s[36:39], s28 offen offset:1024 sc1
    buffer_load_dwordx4 a[120:123], v4, s[36:39], s28 offen offset:2048 sc1
    buffer_load_dwordx4 a[124:127], v4, s[36:39], s28 offen offset:3072 sc1
    s_add_u32 s28, s61, 32768
    buffer_load_dwordx4 a[128:131], v4, s[36:39], s28 offen offset:0 sc1
    buffer_load_dwordx4 a[132:135], v4, s[36:39], s28 offen offset:1024 sc1
    buffer_load_dwordx4 a[136:139], v4, s[36:39], s28 offen offset:2048 sc1
    buffer_load_dwordx4 a[140:143], v4, s[36:39], s28 offen offset:3072 sc1
    s_add_u32 s28, s61, 36864
    buffer_load_dwordx4 a[144:147], v4, s[36:39], s28 offen offset:0 sc1
    buffer_load_dwordx4 a[148:151], v4, s[36:39], s28 offen offset:1024 sc1
    buffer_load_dwordx4 a[152:155], v4, s[36:39], s28 offen offset:2048 sc1
    buffer_load_dwordx4 a[156:159], v4, s[36:39], s28 offen offset:3072 sc1
    s_add_u32 s28, s61, 40960
    buffer_load_dwordx4 a[160:163], v4, s[36:39], s28 offen offset:0 sc1
    buffer_load_dwordx4 a[164:167], v4, s[36:39], s28 offen offset:1024 sc1
    buffer_load_dwordx4 a[168:171], v4, s[36:39], s28 offen offset:2048 sc1
    buffer_load_dwordx4 a[172:175], v4, s[36:39], s28 offen offset:3072 sc1
    s_add_u32 s28, s61, 45056
    buffer_load_dwordx4 a[176:179], v4, s[36:39], s28 offen offset:0 sc1
    buffer_load_dwordx4 a[180:183], v4, s[36:39], s28 offen offset:1024 sc1
    buffer_load_dwordx4 a[184:187], v4, s[36:39], s28 offen offset:2048 sc1
    buffer_load_dwordx4 a[188:191], v4, s[36:39], s28 offen offset:3072 sc1
    s_add_u32 s28, s61, 49152
    buffer_load_dwordx4 a[192:195], v4, s[36:39], s28 offen offset:0 sc1
    buffer_load_dwordx4 a[196:199], v4, s[36:39], s28 offen offset:1024 sc1
    buffer_load_dwordx4 a[200:203], v4, s[36:39], s28 offen offset:2048 sc1
    buffer_load_dwordx4 a[204:207], v4, s[36:39], s28 offen offset:3072 sc1
    s_add_u32 s28, s61, 53248
    buffer_load_dwordx4 a[208:211], v4, s[36:39], s28 offen offset:0 sc1
    buffer_load_dwordx4 a[212:215], v4, s[36:39], s28 offen offset:1024 sc1
    buffer_load_dwordx4 a[216:219], v4, s[36:39], s28 offen offset:2048 sc1
    buffer_load_dwordx4 a[220:223], v4, s[36:39], s28 offen offset:3072 sc1
E3_W0:
    s_cmp_lg_u32 s3, 0
    s_cbranch_scc1 E3_DONE
    v_min_u32 v13, 15, v2
    v_lshlrev_b32 v13, 2, v13
    v_and_b32 v12, 31, v1
    v_min_u32 v12, 27, v12
    v_lshlrev_b32 v12, 2, v12
    s_sub_u32 s63, 6144, s34
    v_add_u32 v12, s63, v12
    v_cmp_gt_u32 vcc, 32, v1
    s_nop 1
    v_cndmask_b32 v13, v12, v13, vcc
    s_mov_b32 s63, 0
E3_LOOP:
    buffer_load_dword v12, v13, s[52:55], s34 offen sc1
    s_add_u32 s63, s63, 1
    s_waitcnt vmcnt(0)
    v_cmp_ne_u32 vcc, s96, v12
    s_nop 4
    s_cmp_eq_u64 vcc, 0
    s_cbranch_scc1 E3_DONE
    s_sleep 1
    s_cmp_lt_u32 s63, 0x40000
    s_cbranch_scc1 E3_LOOP
E3_DONE:
    s_barrier
    s_cmp_eq_u32 s33, 0
    s_cselect_b64 vcc, -1, 0
    s_add_u32 m0, s24, 0
    s_add_u32 s27, m0, s25
    buffer_load_dwordx4 v4, s[12:15], s27 offen sc1 lds
    s_add_u32 m0, s24, 14336
    s_add_u32 s27, m0, s25
    buffer_load_dwordx4 v4, s[12:15], s27 offen sc1 lds
    s_add_u32 m0, s24, 1024
    s_add_u32 s27, m0, s25
    buffer_load_dwordx4 v4, s[12:15], s27 offen sc1 lds
    s_add_u32 m0, s24, 15360
    s_add_u32 s27, m0, s25
    buffer_load_dwordx4 v4, s[12:15], s27 offen sc1 lds
    s_add_u32 m0, s24, 2048
    s_add_u32 s27, m0, s25
    buffer_load_dwordx4 v4, s[12:15], s27 offen sc1 lds
    s_add_u32 m0, s24, 16384
    s_add_u32 s27, m0, s25
    buffer_load_dwordx4 v4, s[12:15], s27 offen sc1 lds
    s_add_u32 m0, s24, 3072
    s_add_u32 s27, m0, s25
    buffer_load_dwordx4 v4, s[12:15], s27 offen sc1 lds
    s_add_u32 m0, s24, 17408
    s_add_u32 s27, m0, s25
    buffer_load_dwordx4 v4, s[12:15], s27 offen sc1 lds
    s_add_u32 m0, s24, 4096
    s_add_u32 s27, m0, s25
    buffer_load_dwordx4 v4, s[12:15], s27 offen sc1 lds
    s_add_u32 m0, s24, 18432
    s_add_u32 s27, m0, s25
    buffer_load_dwordx4 v4, s[12:15], s27 offen sc1 lds
    s_add_u32 m0, s24, 5120
    s_add_u32 s27, m0, s25
    buffer_load_dwordx4 v4, s[12:15], s27 offen sc1 lds
    s_add_u32 m0, s24, 19456
    s_add_u32 s27, m0, s25
    buffer_load_dwordx4 v4, s[12:15], s27 offen sc1 lds
    s_waitcnt vmcnt(8)
    s_barrier
    ds_read_b128 v[144:147], v5 offset:0
    ds_read_b128 v[148:151], v5 offset:28672
    ds_read_b128 v[152:155], v6 offset:0
    ds_read_b128 v[156:159], v6 offset:28672
    ds_read_b128 v[160:163], v5 offset:512
    ds_read_b128 v[164:167], v5 offset:29184
    ds_read_b128 v[168:171], v6 offset:512
    ds_read_b128 v[172:175], v6 offset:29184
    s_waitcnt lgkmcnt(0)
    v_mfma_f32_32x32x16_bf16 v[16:31], a[0:3], v[144:147], 0
    ds_read_b128 v[176:179], v5 offset:1024
    buffer_load_dwordx4 v[232:235], v11, s[40:43], s29 offen offset:0 sc1
    v_mfma_f32_32x32x16_bf16 v[32:47], a[4:7], v[144:147], 0
    ds_read_b128 v[180:183], v5 offset:29696
    v_mfma_f32_32x32x16_bf16 v[48:63], a[0:3], v[148:151], 0
    ds_read_b128 v[184:187], v6 offset:1024
    buffer_load_dwordx4 v[236:239], v11, s[40:43], s29 offen offset:16 sc1
    v_mfma_f32_32x32x16_bf16 v[64:79], a[4:7], v[148:151], 0
    ds_read_b128 v[188:191], v6 offset:29696
    v_mfma_f32_32x32x16_bf16 v[80:95], a[0:3], v[152:155], 0
    ds_read_b128 v[192:195], v5 offset:1536
    v_mfma_f32_32x32x16_bf16 v[96:111], a[4:7], v[152:155], 0
    ds_read_b128 v[196:199], v5 offset:30208
    s_add_u32 m0, s24, 6144
    s_add_u32 s27, m0, s25
    buffer_load_dwordx4 v4, s[12:15], s27 offen sc1 lds
    s_cbranch_vccz P4_SK7
    s_add_u32 s62, s61, 28672
    buffer_load_dwordx4 a[112:115], v4, s[36:39], s62 offen offset:0 sc1
    buffer_load_dwordx4 a[116:119], v4, s[36:39], s62 offen offset:1024 sc1
    buffer_load_dwordx4 a[120:123], v4, s[36:39], s62 offen offset:2048 sc1
    buffer_load_dwordx4 a[124:127], v4, s[36:39], s62 offen offset:3072 sc1
P4_SK7:
    v_mfma_f32_32x32x16_bf16 v[112:127], a[0:3], v[156:159], 0
    ds_read_b128 v[200:203], v6 offset:1536
    v_mfma_f32_32x32x16_bf16 v[128:143], a[4:7], v[156:159], 0
    ds_read_b128 v[204:207], v6 offset:30208
    v_mfma_f32_32x32x16_bf16 v[16:31], a[8:11], v[160:163], v[16:31]
    s_add_u32 m0, s24, 20480
    s_add_u32 s27, m0, s25
    buffer_load_dwordx4 v4, s[12:15], s27 offen sc1 lds
    v_mfma_f32_32x32x16_bf16 v[32:47], a[12:15], v[160:163], v[32:47]
    v_mfma_f32_32x32x16_bf16 v[48:63], a[8:11], v[164:167], v[48:63]
    s_add_u32 m0, s24, 7168
    s_add_u32 s27, m0, s25
    buffer_load_dwordx4 v4, s[12:15], s27 offen sc1 lds
    v_mfma_f32_32x32x16_bf16 v[64:79], a[12:15], v[164:167], v[64:79]
    v_mfma_f32_32x32x16_bf16 v[80:95], a[8:11], v[168:171], v[80:95]
    v_mfma_f32_32x32x16_bf16 v[96:111], a[12:15], v[168:171], v[96:111]
    s_add_u32 m0, s24, 21504
    s_add_u32 s27, m0, s25
    buffer_load_dwordx4 v4, s[12:15], s27 offen sc1 lds
    v_mfma_f32_32x32x16_bf16 v[112:127], a[8:11], v[172:175], v[112:127]
    v_mfma_f32_32x32x16_bf16 v[128:143], a[12:15], v[172:175], v[128:143]
    s_waitcnt vmcnt(10)
    s_barrier
    s_waitcnt lgkmcnt(0)
    v_mfma_f32_32x32x16_bf16 v[16:31], a[16:19], v[176:179], v[16:31]
    ds_read_b128 v[144:147], v5 offset:2048
    s_add_u32 m0, s24, 8192
    s_add_u32 s27, m0, s25
    buffer_load_dwordx4 v4, s[12:15], s27 offen sc1 lds
    v_mfma_f32_32x32x16_bf16 v[32:47], a[20:23], v[176:179], v[32:47]
    ds_read_b128 v[148:151], v5 offset:30720
    v_mfma_f32_32x32x16_bf16 v[48:63], a[16:19], v[180:183], v[48:63]
    ds_read_b128 v[152:155], v6 offset:2048
    v_mfma_f32_32x32x16_bf16 v[64:79], a[20:23], v[180:183], v[64:79]
    ds_read_b128 v[156:159], v6 offset:30720
    v_mfma_f32_32x32x16_bf16 v[80:95], a[16:19], v[184:187], v[80:95]
    ds_read_b128 v[160:163], v5 offset:2560
    s_add_u32 m0, s24, 22528
    s_add_u32 s27, m0, s25
    buffer_load_dwordx4 v4, s[12:15], s27 offen sc1 lds
    v_mfma_f32_32x32x16_bf16 v[96:111], a[20:23], v[184:187], v[96:111]
    ds_read_b128 v[164:167], v5 offset:31232
    s_cbranch_vccz P4_SK8
    s_add_u32 s62, s61, 32768
    buffer_load_dwordx4 a[128:131], v4, s[36:39], s62 offen offset:0 sc1
    buffer_load_dwordx4 a[132:135], v4, s[36:39], s62 offen offset:1024 sc1
    buffer_load_dwordx4 a[136:139], v4, s[36:39], s62 offen offset:2048 sc1
    buffer_load_dwordx4 a[140:143], v4, s[36:39], s62 offen offset:3072 sc1
P4_SK8:
    v_mfma_f32_32x32x16_bf16 v[112:127], a[16:19], v[188:191], v[112:127]
    ds_read_b128 v[168:171], v6 offset:2560
    v_mfma_f32_32x32x16_bf16 v[128:143], a[20:23], v[188:191], v[128:143]
    ds_read_b128 v[172:175], v6 offset:31232
    v_mfma_f32_32x32x16_bf16 v[16:31], a[24:27], v[192:195], v[16:31]
    s_add_u32 m0, s24, 9216
    s_add_u32 s27, m0, s25
    buffer_load_dwordx4 v4, s[12:15], s27 offen sc1 lds
    v_mfma_f32_32x32x16_bf16 v[32:47], a[28:31], v[192:195], v[32:47]
    v_mfma_f32_32x32x16_bf16 v[48:63], a[24:27], v[196:199], v[48:63]
    v_mfma_f32_32x32x16_bf16 v[64:79], a[28:31], v[196:199], v[64:79]
    v_mfma_f32_32x32x16_bf16 v[80:95], a[24:27], v[200:203], v[80:95]
    s_add_u32 m0, s24, 23552
    s_add_u32 s27, m0, s25
    buffer_load_dwordx4 v4, s[12:15], s27 offen sc1 lds
    v_mfma_f32_32x32x16_bf16 v[96:111], a[28:31], v[200:203], v[96:111]
    v_mfma_f32_32x32x16_bf16 v[112:127], a[24:27], v[204:207], v[112:127]
    v_mfma_f32_32x32x16_bf16 v[128:143], a[28:31], v[204:207], v[128:143]
    s_waitcnt lgkmcnt(0)
    v_mfma_f32_32x32x16_bf16 v[16:31], a[32:35], v[144:147], v[16:31]
    ds_read_b128 v[176:179], v5 offset:3072
    s_add_u32 m0, s24, 10240
    s_add_u32 s27, m0, s25
    buffer_load_dwordx4 v4, s[12:15], s27 offen sc1 lds
    v_mfma_f32_32x32x16_bf16 v[32:47], a[36:39], v[144:147], v[32:47]
    ds_read_b128 v[180:183], v5 offset:31744
    v_mfma_f32_32x32x16_bf16 v[48:63], a[32:35], v[148:151], v[48:63]
    ds_read_b128 v[184:187], v6 offset:3072
    s_add_u32 m0, s24, 24576
    s_add_u32 s27, m0, s25
    buffer_load_dwordx4 v4, s[12:15], s27 offen sc1 lds
    v_mfma_f32_32x32x16_bf16 v[64:79], a[36:39], v[148:151], v[64:79]
    ds_read_b128 v[188:191], v6 offset:31744
    v_mfma_f32_32x32x16_bf16 v[80:95], a[32:35], v[152:155], v[80:95]
    ds_read_b128 v[192:195], v5 offset:3584
    s_add_u32 m0, s24, 11264
    s_add_u32 s27, m0, s25
    buffer_load_dwordx4 v4, s[12:15], s27 offen sc1 lds
    v_mfma_f32_32x32x16_bf16 v[96:111], a[36:39], v[152:155], v[96:111]
    ds_read_b128 v[196:199], v5 offset:32256
    s_cbranch_vccz P4_SK9
    s_add_u32 s62, s61, 36864
    buffer_load_dwordx4 a[144:147], v4, s[36:39], s62 offen offset:0 sc1
    buffer_load_dwordx4 a[148:151], v4, s[36:39], s62 offen offset:1024 sc1
    buffer_load_dwordx4 a[152:155], v4, s[36:39], s62 offen offset:2048 sc1
    buffer_load_dwordx4 a[156:159], v4, s[36:39], s62 offen offset:3072 sc1
P4_SK9:
    v_mfma_f32_32x32x16_bf16 v[112:127], a[32:35], v[156:159], v[112:127]
    ds_read_b128 v[200:203], v6 offset:3584
    s_add_u32 m0, s24, 25600
    s_add_u32 s27, m0, s25
    buffer_load_dwordx4 v4, s[12:15], s27 offen sc1 lds
    v_mfma_f32_32x32x16_bf16 v[128:143], a[36:39], v[156:159], v[128:143]
    ds_read_b128 v[204:207], v6 offset:32256
    v_mfma_f32_32x32x16_bf16 v[16:31], a[40:43], v[160:163], v[16:31]
    s_add_u32 s47, s31, 0
    s_cmp_ge_u32 s47, 14
    s_cselect_b32 s26, 14, 0
    s_sub_u32 s47, s47, s26
    s_lshl_b32 s47, s47, 12
    s_add_u32 s47, s47, s46
    buffer_load_dwordx4 a[0:3], v4, s[16:19], s47 offen offset:0 sc1
    v_mfma_f32_32x32x16_bf16 v[32:47], a[44:47], v[160:163], v[32:47]
    v_mfma_f32_32x32x16_bf16 v[48:63], a[40:43], v[164:167], v[48:63]
    buffer_load_dwordx4 a[4:7], v4, s[16:19], s47 offen offset:1024 sc1
    v_mfma_f32_32x32x16_bf16 v[64:79], a[44:47], v[164:167], v[64:79]
    v_mfma_f32_32x32x16_bf16 v[80:95], a[40:43], v[168:171], v[80:95]
    buffer_load_dwordx4 a[8:11], v4, s[16:19], s47 offen offset:2048 sc1
    v_mfma_f32_32x32x16_bf16 v[96:111], a[44:47], v[168:171], v[96:111]
    v_mfma_f32_32x32x16_bf16 v[112:127], a[40:43], v[172:175], v[112:127]
    buffer_load_dwordx4 a[12:15], v4, s[16:19], s47 offen offset:3072 sc1
    v_mfma_f32_32x32x16_bf16 v[128:143], a[44:47], v[172:175], v[128:143]
    s_waitcnt vmcnt(18)
    s_barrier
    s_waitcnt lgkmcnt(0)
    v_mfma_f32_32x32x16_bf16 v[16:31], a[48:51], v[176:179], v[16:31]
    ds_read_b128 v[144:147], v5 offset:4096
    s_add_u32 m0, s24, 12288
    s_add_u32 s27, m0, s25
    buffer_load_dwordx4 v4, s[12:15], s27 offen sc1 lds
    v_mfma_f32_32x32x16_bf16 v[32:47], a[52:55], v[176:179], v[32:47]
    ds_read_b128 v[148:151], v5 offset:32768
    v_mfma_f32_32x32x16_bf16 v[48:63], a[48:51], v[180:183], v[48:63]
    ds_read_b128 v[152:155], v6 offset:4096
    s_add_u32 m0, s24, 26624
    s_add_u32 s27, m0, s25
    buffer_load_dwordx4 v4, s[12:15], s27 offen sc1 lds
    v_mfma_f32_32x32x16_bf16 v[64:79], a[52:55], v[180:183], v[64:79]
    ds_read_b128 v[156:159], v6 offset:32768
    v_mfma_f32_32x32x16_bf16 v[80:95], a[48:51], v[184:187], v[80:95]
    ds_read_b128 v[160:163], v5 offset:4608
    s_add_u32 m0, s24, 13312
    s_add_u32 s27, m0, s25
    buffer_load_dwordx4 v4, s[12:15], s27 offen sc1 lds
    v_mfma_f32_32x32x16_bf16 v[96:111], a[52:55], v[184:187], v[96:111]
    ds_read_b128 v[164:167], v5 offset:33280
    s_cbranch_vccz P4_SK10
    s_add_u32 s62, s61, 40960
    buffer_load_dwordx4 a[160:163], v4, s[36:39], s62 offen offset:0 sc1
    buffer_load_dwordx4 a[164:167], v4, s[36:39], s62 offen offset:1024 sc1
    buffer_load_dwordx4 a[168:171], v4, s[36:39], s62 offen offset:2048 sc1
    buffer_load_dwordx4 a[172:175], v4, s[36:39], s62 offen offset:3072 sc1
P4_SK10:
    v_mfma_f32_32x32x16_bf16 v[112:127], a[48:51], v[188:191], v[112:127]
    ds_read_b128 v[168:171], v6 offset:4608
    s_add_u32 m0, s24, 27648
    s_add_u32 s27, m0, s25
    buffer_load_dwordx4 v4, s[12:15], s27 offen sc1 lds
    v_mfma_f32_32x32x16_bf16 v[128:143], a[52:55], v[188:191], v[128:143]
    ds_read_b128 v[172:175], v6 offset:33280
    v_mfma_f32_32x32x16_bf16 v[16:31], a[56:59], v[192:195], v[16:31]
    s_add_u32 s47, s31, 1
    s_cmp_ge_u32 s47, 14
    s_cselect_b32 s26, 14, 0
    s_sub_u32 s47, s47, s26
    s_lshl_b32 s47, s47, 12
    s_add_u32 s47, s47, s46
    buffer_load_dwordx4 a[16:19], v4, s[16:19], s47 offen offset:0 sc1
    v_mfma_f32_32x32x16_bf16 v[32:47], a[60:63], v[192:195], v[32:47]
    v_mfma_f32_32x32x16_bf16 v[48:63], a[56:59], v[196:199], v[48:63]
    buffer_load_dwordx4 a[20:23], v4, s[16:19], s47 offen offset:1024 sc1
    v_mfma_f32_32x32x16_bf16 v[64:79], a[60:63], v[196:199], v[64:79]
    v_mfma_f32_32x32x16_bf16 v[80:95], a[56:59], v[200:203], v[80:95]
    buffer_load_dwordx4 a[24:27], v4, s[16:19], s47 offen offset:2048 sc1
    v_mfma_f32_32x32x16_bf16 v[96:111], a[60:63], v[200:203], v[96:111]
    v_mfma_f32_32x32x16_bf16 v[112:127], a[56:59], v[204:207], v[112:127]
    buffer_load_dwordx4 a[28:31], v4, s[16:19], s47 offen offset:3072 sc1
    v_mfma_f32_32x32x16_bf16 v[128:143], a[60:63], v[204:207], v[128:143]
    s_waitcnt lgkmcnt(0)
    v_mfma_f32_32x32x16_bf16 v[16:31], a[64:67], v[144:147], v[16:31]
    ds_read_b128 v[176:179], v5 offset:5120
    s_add_u32 s47, s31, 2
    s_cmp_ge_u32 s47, 14
    s_cselect_b32 s26, 14, 0
    s_sub_u32 s47, s47, s26
    s_lshl_b32 s47, s47, 12
    s_add_u32 s47, s47, s46
    buffer_load_dwordx4 a[32:35], v4, s[16:19], s47 offen offset:0 sc1
    v_mfma_f32_32x32x16_bf16 v[32:47], a[68:71], v[144:147], v[32:47]
    ds_read_b128 v[180:183], v5 offset:33792
    v_mfma_f32_32x32x16_bf16 v[48:63], a[64:67], v[148:151], v[48:63]
    ds_read_b128 v[184:187], v6 offset:5120
    v_mfma_f32_32x32x16_bf16 v[64:79], a[68:71], v[148:151], v[64:79]
    ds_read_b128 v[188:191], v6 offset:33792
    v_mfma_f32_32x32x16_bf16 v[80:95], a[64:67], v[152:155], v[80:95]
    ds_read_b128 v[192:195], v5 offset:5632
    buffer_load_dwordx4 a[36:39], v4, s[16:19], s47 offen offset:1024 sc1
    v_mfma_f32_32x32x16_bf16 v[96:111], a[68:71], v[152:155], v[96:111]
    ds_read_b128 v[196:199], v5 offset:34304
    s_cbranch_vccz P4_SK11
    s_add_u32 s62, s61, 45056
    buffer_load_dwordx4 a[176:179], v4, s[36:39], s62 offen offset:0 sc1
    buffer_load_dwordx4 a[180:183], v4, s[36:39], s62 offen offset:1024 sc1
    buffer_load_dwordx4 a[184:187], v4, s[36:39], s62 offen offset:2048 sc1
    buffer_load_dwordx4 a[188:191], v4, s[36:39], s62 offen offset:3072 sc1
P4_SK11:
    v_mfma_f32_32x32x16_bf16 v[112:127], a[64:67], v[156:159], v[112:127]
    ds_read_b128 v[200:203], v6 offset:5632
    v_mfma_f32_32x32x16_bf16 v[128:143], a[68:71], v[156:159], v[128:143]
    ds_read_b128 v[204:207], v6 offset:34304
    v_mfma_f32_32x32x16_bf16 v[16:31], a[72:75], v[160:163], v[16:31]
    buffer_load_dwordx4 a[40:43], v4, s[16:19], s47 offen offset:2048 sc1
    v_mfma_f32_32x32x16_bf16 v[32:47], a[76:79], v[160:163], v[32:47]
    v_mfma_f32_32x32x16_bf16 v[48:63], a[72:75], v[164:167], v[48:63]
    v_mfma_f32_32x32x16_bf16 v[64:79], a[76:79], v[164:167], v[64:79]
    v_mfma_f32_32x32x16_bf16 v[80:95], a[72:75], v[168:171], v[80:95]
    buffer_load_dwordx4 a[44:47], v4, s[16:19], s47 offen offset:3072 sc1
    v_mfma_f32_32x32x16_bf16 v[96:111], a[76:79], v[168:171], v[96:111]
    v_mfma_f32_32x32x16_bf16 v[112:127], a[72:75], v[172:175], v[112:127]
    v_mfma_f32_32x32x16_bf16 v[128:143], a[76:79], v[172:175], v[128:143]
    s_waitcnt vmcnt(24)
    s_barrier
    s_waitcnt lgkmcnt(0)
    v_mfma_f32_32x32x16_bf16 v[16:31], a[80:83], v[176:179], v[16:31]
    ds_read_b128 v[144:147], v5 offset:6144
    s_add_u32 s47, s31, 3
    s_cmp_ge_u32 s47, 14
    s_cselect_b32 s26, 14, 0
    s_sub_u32 s47, s47, s26
    s_lshl_b32 s47, s47, 12
    s_add_u32 s47, s47, s46
    buffer_load_dwordx4 a[48:51], v4, s[16:19], s47 offen offset:0 sc1
    v_mfma_f32_32x32x16_bf16 v[32:47], a[84:87], v[176:179], v[32:47]
    ds_read_b128 v[148:151], v5 offset:34816
    v_mfma_f32_32x32x16_bf16 v[48:63], a[80:83], v[180:183], v[48:63]
    ds_read_b128 v[152:155], v6 offset:6144
    v_mfma_f32_32x32x16_bf16 v[64:79], a[84:87], v[180:183], v[64:79]
    ds_read_b128 v[156:159], v6 offset:34816
    v_mfma_f32_32x32x16_bf16 v[80:95], a[80:83], v[184:187], v[80:95]
    ds_read_b128 v[160:163], v5 offset:6656
    buffer_load_dwordx4 a[52:55], v4, s[16:19], s47 offen offset:1024 sc1
    v_mfma_f32_32x32x16_bf16 v[96:111], a[84:87], v[184:187], v[96:111]
    ds_read_b128 v[164:167], v5 offset:35328
    s_cbranch_vccz P4_SK12
    s_add_u32 s62, s61, 49152
    buffer_load_dwordx4 a[192:195], v4, s[36:39], s62 offen offset:0 sc1
    buffer_load_dwordx4 a[196:199], v4, s[36:39], s62 offen offset:1024 sc1
    buffer_load_dwordx4 a[200:203], v4, s[36:39], s62 offen offset:2048 sc1
    buffer_load_dwordx4 a[204:207], v4, s[36:39], s62 offen offset:3072 sc1
P4_SK12:
    v_mfma_f32_32x32x16_bf16 v[112:127], a[80:83], v[188:191], v[112:127]
    ds_read_b128 v[168:171], v6 offset:6656
    v_mfma_f32_32x32x16_bf16 v[128:143], a[84:87], v[188:191], v[128:143]
    ds_read_b128 v[172:175], v6 offset:35328
    v_mfma_f32_32x32x16_bf16 v[16:31], a[88:91], v[192:195], v[16:31]
    buffer_load_dwordx4 a[56:59], v4, s[16:19], s47 offen offset:2048 sc1
    v_mfma_f32_32x32x16_bf16 v[32:47], a[92:95], v[192:195], v[32:47]
    v_mfma_f32_32x32x16_bf16 v[48:63], a[88:91], v[196:199], v[48:63]
    v_mfma_f32_32x32x16_bf16 v[64:79], a[92:95], v[196:199], v[64:79]
    v_mfma_f32_32x32x16_bf16 v[80:95], a[88:91], v[200:203], v[80:95]
    buffer_load_dwordx4 a[60:63], v4, s[16:19], s47 offen offset:3072 sc1
    v_mfma_f32_32x32x16_bf16 v[96:111], a[92:95], v[200:203], v[96:111]
    v_mfma_f32_32x32x16_bf16 v[112:127], a[88:91], v[204:207], v[112:127]
    v_mfma_f32_32x32x16_bf16 v[128:143], a[92:95], v[204:207], v[128:143]
    s_waitcnt lgkmcnt(0)
    v_mfma_f32_32x32x16_bf16 v[16:31], a[96:99], v[144:147], v[16:31]
    ds_read_b128 v[176:179], v5 offset:7168
    s_add_u32 s47, s31, 4
    s_cmp_ge_u32 s47, 14
    s_cselect_b32 s26, 14, 0
    s_sub_u32 s47, s47, s26
    s_lshl_b32 s47, s47, 12
    s_add_u32 s47, s47, s46
    buffer_load_dwordx4 a[64:67], v4, s[16:19], s47 offen offset:0 sc1
    v_add_f32 v232, v232, v234
    v_add_f32 v233, v233, v235
    v_mfma_f32_32x32x16_bf16 v[32:47], a[100:103], v[144:147], v[32:47]
    ds_read_b128 v[180:183], v5 offset:35840
    v_add_f32 v236, v236, v238
    v_add_f32 v237, v237, v239
    v_mfma_f32_32x32x16_bf16 v[48:63], a[96:99], v[148:151], v[48:63]
    ds_read_b128 v[184:187], v6 offset:7168
    v_add_f32 v232, v232, v236
    v_add_f32 v233, v233, v237
    v_mfma_f32_32x32x16_bf16 v[64:79], a[100:103], v[148:151], v[64:79]
    ds_read_b128 v[188:191], v6 offset:35840
    v_mov_b32 v234, v232
    v_mov_b32 v235, v233
    v_mfma_f32_32x32x16_bf16 v[80:95], a[96:99], v[152:155], v[80:95]
    ds_read_b128 v[192:195], v5 offset:7680
    buffer_load_dwordx4 a[68:71], v4, s[16:19], s47 offen offset:1024 sc1
    v_permlane32_swap_b32 v232, v234
    v_permlane32_swap_b32 v233, v235
    v_mfma_f32_32x32x16_bf16 v[96:111], a[100:103], v[152:155], v[96:111]
    ds_read_b128 v[196:199], v5 offset:36352
    s_cbranch_vccz P4_SK13
    s_add_u32 s62, s61, 53248
    buffer_load_dwordx4 a[208:211], v4, s[36:39], s62 offen offset:0 sc1
    buffer_load_dwordx4 a[212:215], v4, s[36:39], s62 offen offset:1024 sc1
    buffer_load_dwordx4 a[216:219], v4, s[36:39], s62 offen offset:2048 sc1
    buffer_load_dwordx4 a[220:223], v4, s[36:39], s62 offen offset:3072 sc1
P4_SK13:
    v_add_f32 v232, v232, v234
    v_add_f32 v233, v233, v235
    v_mfma_f32_32x32x16_bf16 v[112:127], a[96:99], v[156:159], v[112:127]
    ds_read_b128 v[200:203], v6 offset:7680
    v_mul_f32 v232, 0x3b124925, v232
    v_mul_f32 v233, 0x3b124925, v233
    v_mfma_f32_32x32x16_bf16 v[128:143], a[100:103], v[156:159], v[128:143]
    ds_read_b128 v[204:207], v6 offset:36352
    v_fma_f32 v233, -v232, v232, v233
    v_max_f32 v233, 0, v233
    v_mfma_f32_32x32x16_bf16 v[16:31], a[104:107], v[160:163], v[16:31]
    buffer_load_dwordx4 a[72:75], v4, s[16:19], s47 offen offset:2048 sc1
    v_cvt_pk_bf16_f32 v233, v233, v233
    v_and_b32 v233, 0xffff0000, v233
    v_mfma_f32_32x32x16_bf16 v[32:47], a[108:111], v[160:163], v[32:47]
    v_add_f32 v233, 0x3727c5ac, v233
    v_cvt_pk_bf16_f32 v233, v233, v233
    v_mfma_f32_32x32x16_bf16 v[48:63], a[104:107], v[164:167], v[48:63]
    v_and_b32 v233, 0xffff0000, v233
    v_sqrt_f32 v233, v233
    v_mfma_f32_32x32x16_bf16 v[64:79], a[108:111], v[164:167], v[64:79]
    v_cvt_pk_bf16_f32 v233, v233, v233
    v_and_b32 v233, 0xffff0000, v233
    v_mfma_f32_32x32x16_bf16 v[80:95], a[104:107], v[168:171], v[80:95]
    buffer_load_dwordx4 a[76:79], v4, s[16:19], s47 offen offset:3072 sc1
    v_rcp_f32 v232, v233
    s_nop 0
    v_mul_f32 v232, 0xbfb8aa3b, v232
    v_mfma_f32_32x32x16_bf16 v[96:111], a[108:111], v[168:171], v[96:111]
    v_and_b32 v12, 31, v1
    v_lshlrev_b32 v12, 3, v12
    v_mfma_f32_32x32x16_bf16 v[112:127], a[104:107], v[172:175], v[112:127]
    v_add_u32 v12, 57344, v12
    s_lshl_b32 s30, s3, 8
    v_mfma_f32_32x32x16_bf16 v[128:143], a[108:111], v[172:175], v[128:143]
    v_add_u32 v13, s30, v12
    s_mul_i32 s29, s58, 448
    s_waitcnt vmcnt(35)
    s_waitcnt lgkmcnt(0)
    v_mfma_f32_32x32x16_bf16 v[16:31], a[112:115], v[176:179], v[16:31]
    s_add_u32 s47, s31, 5
    s_cmp_ge_u32 s47, 14
    s_cselect_b32 s26, 14, 0
    s_sub_u32 s47, s47, s26
    s_lshl_b32 s47, s47, 12
    s_add_u32 s47, s47, s46
    buffer_load_dwordx4 a[80:83], v4, s[16:19], s47 offen offset:0 sc1
    s_add_u32 s29, s29, s60
    s_lshl_b32 s29, s29, 10
    v_mfma_f32_32x32x16_bf16 v[32:47], a[116:119], v[176:179], v[32:47]
    v_mfma_f32_32x32x16_bf16 v[48:63], a[112:115], v[180:183], v[48:63]
    v_mfma_f32_32x32x16_bf16 v[64:79], a[116:119], v[180:183], v[64:79]
    v_mfma_f32_32x32x16_bf16 v[80:95], a[112:115], v[184:187], v[80:95]
    buffer_load_dwordx4 a[84:87], v4, s[16:19], s47 offen offset:1024 sc1
    v_mfma_f32_32x32x16_bf16 v[96:111], a[116:119], v[184:187], v[96:111]
    v_mfma_f32_32x32x16_bf16 v[112:127], a[112:115], v[188:191], v[112:127]
    v_mfma_f32_32x32x16_bf16 v[128:143], a[116:119], v[188:191], v[128:143]
    v_mfma_f32_32x32x16_bf16 v[16:31], a[120:123], v[192:195], v[16:31]
    buffer_load_dwordx4 a[88:91], v4, s[16:19], s47 offen offset:2048 sc1
    v_mfma_f32_32x32x16_bf16 v[32:47], a[124:127], v[192:195], v[32:47]
    v_mfma_f32_32x32x16_bf16 v[48:63], a[120:123], v[196:199], v[48:63]
    v_mfma_f32_32x32x16_bf16 v[64:79], a[124:127], v[196:199], v[64:79]
    v_mfma_f32_32x32x16_bf16 v[80:95], a[120:123], v[200:203], v[80:95]
    buffer_load_dwordx4 a[92:95], v4, s[16:19], s47 offen offset:3072 sc1
    v_mfma_f32_32x32x16_bf16 v[96:111], a[124:127], v[200:203], v[96:111]
    v_mfma_f32_32x32x16_bf16 v[112:127], a[120:123], v[204:207], v[112:127]
    v_mfma_f32_32x32x16_bf16 v[128:143], a[124:127], v[204:207], v[128:143]
    ds_write_b64 v13, v[232:233] offset:57344
    s_waitcnt vmcnt(6) lgkmcnt(0)
    s_barrier
    ds_read_b64 v[224:225], v12 offset:57344
    ds_read_b64 v[226:227], v12 offset:57600
    ds_read_b64 v[228:229], v12 offset:57856
    ds_read_b64 v[230:231], v12 offset:58112
    ds_read_b128 v[144:147], v5 offset:8192
    ds_read_b128 v[148:151], v5 offset:8704
    ds_read_b128 v[152:155], v5 offset:9216
    ds_read_b128 v[156:159], v5 offset:9728
    ds_read_b128 v[160:163], v5 offset:10240
    ds_read_b128 v[164:167], v5 offset:10752
    ds_read_b128 v[168:171], v5 offset:11264
    ds_read_b128 v[172:175], v5 offset:11776
    ds_read_b128 v[176:179], v5 offset:12288
    ds_read_b128 v[180:183], v5 offset:12800
    s_waitcnt lgkmcnt(8)
    v_mfma_f32_32x32x16_bf16 v[16:31], a[128:131], v[144:147], v[16:31]
    v_mfma_f32_32x32x16_bf16 v[32:47], a[132:135], v[144:147], v[32:47]
    ds_read_b128 v[144:147], v5 offset:13312
    v_mfma_f32_32x32x16_bf16 v[16:31], a[136:139], v[148:151], v[16:31]
    s_add_u32 s47, s31, 6
    s_cmp_ge_u32 s47, 14
    s_cselect_b32 s26, 14, 0
    s_sub_u32 s47, s47, s26
    s_lshl_b32 s47, s47, 12
    s_add_u32 s47, s47, s46
    buffer_load_dwordx4 a[96:99], v4, s[16:19], s47 offen offset:0 sc1
    v_mfma_f32_32x32x16_bf16 v[32:47], a[140:143], v[148:151], v[32:47]
    ds_read_b128 v[148:151], v5 offset:13824
    s_waitcnt lgkmcnt(8)
    v_mfma_f32_32x32x16_bf16 v[16:31], a[144:147], v[152:155], v[16:31]
    v_mfma_f32_32x32x16_bf16 v[32:47], a[148:151], v[152:155], v[32:47]
    ds_read_b128 v[152:155], v5 offset:36864
    buffer_load_dwordx4 a[100:103], v4, s[16:19], s47 offen offset:1024 sc1
    v_mfma_f32_32x32x16_bf16 v[16:31], a[152:155], v[156:159], v[16:31]
    buffer_load_dwordx4 a[104:107], v4, s[16:19], s47 offen offset:2048 sc1
    buffer_load_dwordx4 a[108:111], v4, s[16:19], s47 offen offset:3072 sc1
    v_mfma_f32_32x32x16_bf16 v[32:47], a[156:159], v[156:159], v[32:47]
    ds_read_b128 v[156:159], v5 offset:37376
    s_waitcnt lgkmcnt(8)
    v_mfma_f32_32x32x16_bf16 v[16:31], a[160:163], v[160:163], v[16:31]
    s_add_u32 s47, s31, 7
    s_cmp_ge_u32 s47, 14
    s_cselect_b32 s26, 14, 0
    s_sub_u32 s47, s47, s26
    s_lshl_b32 s47, s47, 12
    s_add_u32 s47, s47, s46
    buffer_load_dwordx4 a[112:115], v4, s[16:19], s47 offen offset:0 sc1
    v_mfma_f32_32x32x16_bf16 v[32:47], a[164:167], v[160:163], v[32:47]
    ds_read_b128 v[160:163], v5 offset:37888
    v_mfma_f32_32x32x16_bf16 v[16:31], a[168:171], v[164:167], v[16:31]
    buffer_load_dwordx4 a[116:119], v4, s[16:19], s47 offen offset:1024 sc1
    v_mfma_f32_32x32x16_bf16 v[32:47], a[172:175], v[164:167], v[32:47]
    ds_read_b128 v[164:167], v5 offset:38400
    buffer_load_dwordx4 a[120:123], v4, s[16:19], s47 offen offset:2048 sc1
    s_waitcnt lgkmcnt(8)
    v_mfma_f32_32x32x16_bf16 v[16:31], a[176:179], v[168:171], v[16:31]
    buffer_load_dwordx4 a[124:127], v4, s[16:19], s47 offen offset:3072 sc1
    v_mfma_f32_32x32x16_bf16 v[32:47], a[180:183], v[168:171], v[32:47]
    ds_read_b128 v[168:171], v5 offset:38912
    v_mfma_f32_32x32x16_bf16 v[16:31], a[184:187], v[172:175], v[16:31]
    s_add_u32 s47, s31, 8
    s_cmp_ge_u32 s47, 14
    s_cselect_b32 s26, 14, 0
    s_sub_u32 s47, s47, s26
    s_lshl_b32 s47, s47, 12
    s_add_u32 s47, s47, s46
    buffer_load_dwordx4 a[224:227], v4, s[16:19], s47 offen offset:0 sc1
    v_mfma_f32_32x32x16_bf16 v[32:47], a[188:191], v[172:175], v[32:47]
    ds_read_b128 v[172:175], v5 offset:39424
    s_waitcnt lgkmcnt(8)
    v_mfma_f32_32x32x16_bf16 v[16:31], a[192:195], v[176:179], v[16:31]
    buffer_load_dwordx4 a[228:231], v4, s[16:19], s47 offen offset:1024 sc1
    v_mfma_f32_32x32x16_bf16 v[32:47], a[196:199], v[176:179], v[32:47]
    ds_read_b128 v[176:179], v5 offset:39936
    buffer_load_dwordx4 a[232:235], v4, s[16:19], s47 offen offset:2048 sc1
    v_mfma_f32_32x32x16_bf16 v[16:31], a[200:203], v[180:183], v[16:31]
    buffer_load_dwordx4 a[236:239], v4, s[16:19], s47 offen offset:3072 sc1
    v_mfma_f32_32x32x16_bf16 v[32:47], a[204:207], v[180:183], v[32:47]
    ds_read_b128 v[180:183], v5 offset:40448
    s_waitcnt lgkmcnt(8)
    v_mfma_f32_32x32x16_bf16 v[16:31], a[208:211], v[144:147], v[16:31]
    s_add_u32 s47, s31, 9
    s_cmp_ge_u32 s47, 14
    s_cselect_b32 s26, 14, 0
    s_sub_u32 s47, s47, s26
    s_lshl_b32 s47, s47, 12
    s_add_u32 s47, s47, s46
    buffer_load_dwordx4 a[240:243], v4, s[16:19], s47 offen offset:0 sc1
    v_mfma_f32_32x32x16_bf16 v[32:47], a[212:215], v[144:147], v[32:47]
    ds_read_b128 v[144:147], v5 offset:40960
    v_mfma_f32_32x32x16_bf16 v[16:31], a[216:219], v[148:151], v[16:31]
    buffer_load_dwordx4 a[244:247], v4, s[16:19], s47 offen offset:1024 sc1
    buffer_load_dwordx4 a[248:251], v4, s[16:19], s47 offen offset:2048 sc1
    v_mfma_f32_32x32x16_bf16 v[32:47], a[220:223], v[148:151], v[32:47]
    ds_read_b128 v[148:151], v5 offset:41472
    buffer_load_dwordx4 a[252:255], v4, s[16:19], s47 offen offset:3072 sc1
    s_waitcnt lgkmcnt(8)
    v_mfma_f32_32x32x16_bf16 v[48:63], a[128:131], v[152:155], v[48:63]
    v_mfma_f32_32x32x16_bf16 v[64:79], a[132:135], v[152:155], v[64:79]
    ds_read_b128 v[152:155], v5 offset:41984
    s_nop 2
    v_mul_f32 v16, v16, v224
    v_mul_f32 v17, v17, v224
    v_exp_f32 v16, v16
    v_mul_f32 v18, v18, v224
    v_mfma_f32_32x32x16_bf16 v[48:63], a[136:139], v[156:159], v[48:63]
    v_exp_f32 v17, v17
    v_mul_f32 v19, v19, v224
    v_exp_f32 v18, v18
    v_fma_f32 v16, v16, v225, v225
    v_mfma_f32_32x32x16_bf16 v[64:79], a[140:143], v[156:159], v[64:79]
    ds_read_b128 v[156:159], v5 offset:42496
    v_mul_f32 v20, v20, v224
    v_exp_f32 v19, v19
    v_fma_f32 v17, v17, v225, v225
    v_rcp_f32 v16, v16
    s_waitcnt lgkmcnt(8)
    v_mfma_f32_32x32x16_bf16 v[48:63], a[144:147], v[160:163], v[48:63]
    v_mul_f32 v21, v21, v224
    v_exp_f32 v20, v20
    v_fma_f32 v18, v18, v225, v225
    v_mfma_f32_32x32x16_bf16 v[64:79], a[148:151], v[160:163], v[64:79]
    ds_read_b128 v[160:163], v6 offset:8192
    v_rcp_f32 v17, v17
    v_mul_f32 v22, v22, v224
    v_exp_f32 v21, v21
    v_mfma_f32_32x32x16_bf16 v[48:63], a[152:155], v[164:167], v[48:63]
    v_fma_f32 v19, v19, v225, v225
    v_rcp_f32 v18, v18
    v_mul_f32 v16, v16, v32
    v_mul_f32 v23, v23, v224
    v_exp_f32 v22, v22
    v_mfma_f32_32x32x16_bf16 v[64:79], a[156:159], v[164:167], v[64:79]
    ds_read_b128 v[164:167], v6 offset:8704
    v_fma_f32 v20, v20, v225, v225
    v_rcp_f32 v19, v19
    v_mul_f32 v17, v17, v33
    v_cvt_pk_bf16_f32 v240, v16, v17
    s_waitcnt lgkmcnt(8)
    v_mfma_f32_32x32x16_bf16 v[48:63], a[160:163], v[168:171], v[48:63]
    v_mul_f32 v24, v24, v224
    v_exp_f32 v23, v23
    v_fma_f32 v21, v21, v225, v225
    v_mfma_f32_32x32x16_bf16 v[64:79], a[164:167], v[168:171], v[64:79]
    ds_read_b128 v[168:171], v6 offset:9216
    v_rcp_f32 v20, v20
    v_mul_f32 v18, v18, v34
    v_mul_f32 v25, v25, v224
    v_exp_f32 v24, v24
    v_mfma_f32_32x32x16_bf16 v[48:63], a[168:171], v[172:175], v[48:63]
    v_fma_f32 v22, v22, v225, v225
    v_rcp_f32 v21, v21
    v_mul_f32 v19, v19, v35
    v_cvt_pk_bf16_f32 v241, v18, v19
    v_mul_f32 v26, v26, v224
    v_mfma_f32_32x32x16_bf16 v[64:79], a[172:175], v[172:175], v[64:79]
    ds_read_b128 v[172:175], v6 offset:9728
    v_exp_f32 v25, v25
    v_fma_f32 v23, v23, v225, v225
    v_rcp_f32 v22, v22
    s_waitcnt lgkmcnt(8)
    v_mfma_f32_32x32x16_bf16 v[48:63], a[176:179], v[176:179], v[48:63]
    v_mul_f32 v20, v20, v36
    v_mul_f32 v27, v27, v224
    v_exp_f32 v26, v26
    v_fma_f32 v24, v24, v225, v225
    v_mfma_f32_32x32x16_bf16 v[64:79], a[180:183], v[176:179], v[64:79]
    ds_read_b128 v[176:179], v6 offset:10240
    v_rcp_f32 v23, v23
    v_mul_f32 v21, v21, v37
    v_cvt_pk_bf16_f32 v242, v20, v21
    v_mul_f32 v28, v28, v224
    v_mfma_f32_32x32x16_bf16 v[48:63], a[184:187], v[180:183], v[48:63]
    v_exp_f32 v27, v27
    v_fma_f32 v25, v25, v225, v225
    v_rcp_f32 v24, v24
    v_mul_f32 v22, v22, v38
    v_mfma_f32_32x32x16_bf16 v[64:79], a[188:191], v[180:183], v[64:79]
    ds_read_b128 v[180:183], v6 offset:10752
    v_mul_f32 v29, v29, v224
    v_exp_f32 v28, v28
    v_fma_f32 v26, v26, v225, v225
    v_rcp_f32 v25, v25
    s_waitcnt lgkmcnt(8)
    v_mfma_f32_32x32x16_bf16 v[48:63], a[192:195], v[144:147], v[48:63]
    v_mul_f32 v23, v23, v39
    v_cvt_pk_bf16_f32 v243, v22, v23
    buffer_store_dwordx4 v[240:243], v10, s[20:23], s29 offen offset:0 sc1
    v_mul_f32 v30, v30, v224
    v_mfma_f32_32x32x16_bf16 v[64:79], a[196:199], v[144:147], v[64:79]
    ds_read_b128 v[144:147], v6 offset:11264
    v_exp_f32 v29, v29
    v_fma_f32 v27, v27, v225, v225
    v_rcp_f32 v26, v26
    v_mfma_f32_32x32x16_bf16 v[48:63], a[200:203], v[148:151], v[48:63]
    v_mul_f32 v24, v24, v40
    v_mul_f32 v31, v31, v224
    v_exp_f32 v30, v30
    v_fma_f32 v28, v28, v225, v225
    v_rcp_f32 v27, v27
    v_mfma_f32_32x32x16_bf16 v[64:79], a[204:207], v[148:151], v[64:79]
    ds_read_b128 v[148:151], v6 offset:11776
    v_mul_f32 v25, v25, v41
    v_cvt_pk_bf16_f32 v244, v24, v25
    v_exp_f32 v31, v31
    v_fma_f32 v29, v29, v225, v225
    s_waitcnt lgkmcnt(8)
    v_mfma_f32_32x32x16_bf16 v[48:63], a[208:211], v[152:155], v[48:63]
    v_rcp_f32 v28, v28
    v_mul_f32 v26, v26, v42
    v_fma_f32 v30, v30, v225, v225
    v_mfma_f32_32x32x16_bf16 v[64:79], a[212:215], v[152:155], v[64:79]
    ds_read_b128 v[152:155], v6 offset:12288
    v_rcp_f32 v29, v29
    v_mul_f32 v27, v27, v43
    v_cvt_pk_bf16_f32 v245, v26, v27
    v_fma_f32 v31, v31, v225, v225
    v_mfma_f32_32x32x16_bf16 v[48:63], a[216:219], v[156:159], v[48:63]
    v_rcp_f32 v30, v30
    v_mul_f32 v28, v28, v44
    v_rcp_f32 v31, v31
    v_mul_f32 v29, v29, v45
    v_cvt_pk_bf16_f32 v246, v28, v29
    v_mfma_f32_32x32x16_bf16 v[64:79], a[220:223], v[156:159], v[64:79]
    ds_read_b128 v[156:159], v6 offset:12800
    v_mul_f32 v30, v30, v46
    v_mul_f32 v31, v31, v47
    v_cvt_pk_bf16_f32 v247, v30, v31
    buffer_store_dwordx4 v[244:247], v10, s[20:23], s29 offen offset:512 sc1
    s_add_u32 s29, s29, 114688
    s_waitcnt lgkmcnt(8)
    v_mfma_f32_32x32x16_bf16 v[80:95], a[128:131], v[160:163], v[80:95]
    v_mfma_f32_32x32x16_bf16 v[96:111], a[132:135], v[160:163], v[96:111]
    ds_read_b128 v[160:163], v6 offset:13312
    v_mul_f32 v48, v48, v226
    v_mul_f32 v49, v49, v226
    v_exp_f32 v48, v48
    v_mul_f32 v50, v50, v226
    v_mfma_f32_32x32x16_bf16 v[80:95], a[136:139], v[164:167], v[80:95]
    v_exp_f32 v49, v49
    v_mul_f32 v51, v51, v226
    v_exp_f32 v50, v50
    v_fma_f32 v48, v48, v227, v227
    v_mfma_f32_32x32x16_bf16 v[96:111], a[140:143], v[164:167], v[96:111]
    ds_read_b128 v[164:167], v6 offset:13824
    v_mul_f32 v52, v52, v226
    v_exp_f32 v51, v51
    v_fma_f32 v49, v49, v227, v227
    v_rcp_f32 v48, v48
    s_waitcnt lgkmcnt(8)
    v_mfma_f32_32x32x16_bf16 v[80:95], a[144:147], v[168:171], v[80:95]
    v_mul_f32 v53, v53, v226
    v_exp_f32 v52, v52
    v_fma_f32 v50, v50, v227, v227
    v_mfma_f32_32x32x16_bf16 v[96:111], a[148:151], v[168:171], v[96:111]
    ds_read_b128 v[168:171], v6 offset:36864
    v_rcp_f32 v49, v49
    v_mul_f32 v54, v54, v226
    v_exp_f32 v53, v53
    v_mfma_f32_32x32x16_bf16 v[80:95], a[152:155], v[172:175], v[80:95]
    v_fma_f32 v51, v51, v227, v227
    v_rcp_f32 v50, v50
    v_mul_f32 v48, v48, v64
    v_mul_f32 v55, v55, v226
    v_exp_f32 v54, v54
    v_mfma_f32_32x32x16_bf16 v[96:111], a[156:159], v[172:175], v[96:111]
    ds_read_b128 v[172:175], v6 offset:37376
    v_fma_f32 v52, v52, v227, v227
    v_rcp_f32 v51, v51
    v_mul_f32 v49, v49, v65
    v_cvt_pk_bf16_f32 v240, v48, v49
    s_waitcnt lgkmcnt(8)
    v_mfma_f32_32x32x16_bf16 v[80:95], a[160:163], v[176:179], v[80:95]
    v_mul_f32 v56, v56, v226
    v_exp_f32 v55, v55
    v_fma_f32 v53, v53, v227, v227
    v_mfma_f32_32x32x16_bf16 v[96:111], a[164:167], v[176:179], v[96:111]
    ds_read_b128 v[176:179], v6 offset:37888
    v_rcp_f32 v52, v52
    v_mul_f32 v50, v50, v66
    v_mul_f32 v57, v57, v226
    v_exp_f32 v56, v56
    v_mfma_f32_32x32x16_bf16 v[80:95], a[168:171], v[180:183], v[80:95]
    v_fma_f32 v54, v54, v227, v227
    v_rcp_f32 v53, v53
    v_mul_f32 v51, v51, v67
    v_cvt_pk_bf16_f32 v241, v50, v51
    v_mul_f32 v58, v58, v226
    v_mfma_f32_32x32x16_bf16 v[96:111], a[172:175], v[180:183], v[96:111]
    ds_read_b128 v[180:183], v6 offset:38400
    v_exp_f32 v57, v57
    v_fma_f32 v55, v55, v227, v227
    v_rcp_f32 v54, v54
    s_waitcnt lgkmcnt(8)
    v_mfma_f32_32x32x16_bf16 v[80:95], a[176:179], v[144:147], v[80:95]
    v_mul_f32 v52, v52, v68
    v_mul_f32 v59, v59, v226
    v_exp_f32 v58, v58
    v_fma_f32 v56, v56, v227, v227
    v_mfma_f32_32x32x16_bf16 v[96:111], a[180:183], v[144:147], v[96:111]
    ds_read_b128 v[144:147], v6 offset:38912
    v_rcp_f32 v55, v55
    v_mul_f32 v53, v53, v69
    v_cvt_pk_bf16_f32 v242, v52, v53
    v_mul_f32 v60, v60, v226
    v_mfma_f32_32x32x16_bf16 v[80:95], a[184:187], v[148:151], v[80:95]
    v_exp_f32 v59, v59
    v_fma_f32 v57, v57, v227, v227
    v_rcp_f32 v56, v56
    v_mul_f32 v54, v54, v70
    v_mfma_f32_32x32x16_bf16 v[96:111], a[188:191], v[148:151], v[96:111]
    ds_read_b128 v[148:151], v6 offset:39424
    v_mul_f32 v61, v61, v226
    v_exp_f32 v60, v60
    v_fma_f32 v58, v58, v227, v227
    v_rcp_f32 v57, v57
    s_waitcnt lgkmcnt(8)
    v_mfma_f32_32x32x16_bf16 v[80:95], a[192:195], v[152:155], v[80:95]
    v_mul_f32 v55, v55, v71
    v_cvt_pk_bf16_f32 v243, v54, v55
    buffer_store_dwordx4 v[240:243], v10, s[20:23], s29 offen offset:0 sc1
    v_mul_f32 v62, v62, v226
    v_mfma_f32_32x32x16_bf16 v[96:111], a[196:199], v[152:155], v[96:111]
    ds_read_b128 v[152:155], v6 offset:39936
    v_exp_f32 v61, v61
    v_fma_f32 v59, v59, v227, v227
    v_rcp_f32 v58, v58
    v_mfma_f32_32x32x16_bf16 v[80:95], a[200:203], v[156:159], v[80:95]
    v_mul_f32 v56, v56, v72
    v_mul_f32 v63, v63, v226
    v_exp_f32 v62, v62
    v_fma_f32 v60, v60, v227, v227
    v_rcp_f32 v59, v59
    v_mfma_f32_32x32x16_bf16 v[96:111], a[204:207], v[156:159], v[96:111]
    ds_read_b128 v[156:159], v6 offset:40448
    v_mul_f32 v57, v57, v73
    v_cvt_pk_bf16_f32 v244, v56, v57
    v_exp_f32 v63, v63
    v_fma_f32 v61, v61, v227, v227
    s_waitcnt lgkmcnt(8)
    v_mfma_f32_32x32x16_bf16 v[80:95], a[208:211], v[160:163], v[80:95]
    v_rcp_f32 v60, v60
    v_mul_f32 v58, v58, v74
    v_fma_f32 v62, v62, v227, v227
    v_mfma_f32_32x32x16_bf16 v[96:111], a[212:215], v[160:163], v[96:111]
    ds_read_b128 v[160:163], v6 offset:40960
    v_rcp_f32 v61, v61
    v_mul_f32 v59, v59, v75
    v_cvt_pk_bf16_f32 v245, v58, v59
    v_fma_f32 v63, v63, v227, v227
    v_mfma_f32_32x32x16_bf16 v[80:95], a[216:219], v[164:167], v[80:95]
    v_rcp_f32 v62, v62
    v_mul_f32 v60, v60, v76
    v_rcp_f32 v63, v63
    v_mul_f32 v61, v61, v77
    v_cvt_pk_bf16_f32 v246, v60, v61
    v_mfma_f32_32x32x16_bf16 v[96:111], a[220:223], v[164:167], v[96:111]
    ds_read_b128 v[164:167], v6 offset:41472
    v_mul_f32 v62, v62, v78
    v_mul_f32 v63, v63, v79
    v_cvt_pk_bf16_f32 v247, v62, v63
    buffer_store_dwordx4 v[244:247], v10, s[20:23], s29 offen offset:512 sc1
    s_add_u32 s29, s29, 114688
    s_waitcnt lgkmcnt(8)
    v_mfma_f32_32x32x16_bf16 v[112:127], a[128:131], v[168:171], v[112:127]
    v_mfma_f32_32x32x16_bf16 v[128:143], a[132:135], v[168:171], v[128:143]
    ds_read_b128 v[168:171], v6 offset:41984
    v_mul_f32 v80, v80, v228
    v_mul_f32 v81, v81, v228
    v_exp_f32 v80, v80
    v_mul_f32 v82, v82, v228
    v_mfma_f32_32x32x16_bf16 v[112:127], a[136:139], v[172:175], v[112:127]
    v_exp_f32 v81, v81
    v_mul_f32 v83, v83, v228
    v_exp_f32 v82, v82
    v_mfma_f32_32x32x16_bf16 v[128:143], a[140:143], v[172:175], v[128:143]
    ds_read_b128 v[172:175], v6 offset:42496
    v_fma_f32 v80, v80, v229, v229
    v_mul_f32 v84, v84, v228
    v_exp_f32 v83, v83
    v_fma_f32 v81, v81, v229, v229
    s_waitcnt lgkmcnt(8)
    v_mfma_f32_32x32x16_bf16 v[112:127], a[144:147], v[176:179], v[112:127]
    v_rcp_f32 v80, v80
    v_mul_f32 v85, v85, v228
    v_exp_f32 v84, v84
    v_mfma_f32_32x32x16_bf16 v[128:143], a[148:151], v[176:179], v[128:143]
    v_fma_f32 v82, v82, v229, v229
    v_rcp_f32 v81, v81
    v_mul_f32 v86, v86, v228
    v_exp_f32 v85, v85
    v_mfma_f32_32x32x16_bf16 v[112:127], a[152:155], v[180:183], v[112:127]
    v_fma_f32 v83, v83, v229, v229
    v_rcp_f32 v82, v82
    v_mul_f32 v80, v80, v96
    v_mul_f32 v87, v87, v228
    v_mfma_f32_32x32x16_bf16 v[128:143], a[156:159], v[180:183], v[128:143]
    v_exp_f32 v86, v86
    v_fma_f32 v84, v84, v229, v229
    v_rcp_f32 v83, v83
    v_mul_f32 v81, v81, v97
    s_waitcnt lgkmcnt(6)
    v_mfma_f32_32x32x16_bf16 v[112:127], a[160:163], v[144:147], v[112:127]
    v_cvt_pk_bf16_f32 v240, v80, v81
    v_mul_f32 v88, v88, v228
    v_exp_f32 v87, v87
    v_mfma_f32_32x32x16_bf16 v[128:143], a[164:167], v[144:147], v[128:143]
    v_fma_f32 v85, v85, v229, v229
    v_rcp_f32 v84, v84
    v_mul_f32 v82, v82, v98
    v_mul_f32 v89, v89, v228
    v_mfma_f32_32x32x16_bf16 v[112:127], a[168:171], v[148:151], v[112:127]
    v_exp_f32 v88, v88
    v_fma_f32 v86, v86, v229, v229
    v_rcp_f32 v85, v85
    v_mul_f32 v83, v83, v99
    v_cvt_pk_bf16_f32 v241, v82, v83
    v_mfma_f32_32x32x16_bf16 v[128:143], a[172:175], v[148:151], v[128:143]
    v_mul_f32 v90, v90, v228
    v_exp_f32 v89, v89
    v_fma_f32 v87, v87, v229, v229
    v_rcp_f32 v86, v86
    s_waitcnt lgkmcnt(4)
    v_mfma_f32_32x32x16_bf16 v[112:127], a[176:179], v[152:155], v[112:127]
    v_mul_f32 v84, v84, v100
    v_mul_f32 v91, v91, v228
    v_exp_f32 v90, v90
    v_mfma_f32_32x32x16_bf16 v[128:143], a[180:183], v[152:155], v[128:143]
    v_fma_f32 v88, v88, v229, v229
    v_rcp_f32 v87, v87
    v_mul_f32 v85, v85, v101
    v_cvt_pk_bf16_f32 v242, v84, v85
    v_mfma_f32_32x32x16_bf16 v[112:127], a[184:187], v[156:159], v[112:127]
    v_mul_f32 v92, v92, v228
    v_exp_f32 v91, v91
    v_fma_f32 v89, v89, v229, v229
    v_rcp_f32 v88, v88
    v_mfma_f32_32x32x16_bf16 v[128:143], a[188:191], v[156:159], v[128:143]
    v_mul_f32 v86, v86, v102
    v_mul_f32 v93, v93, v228
    v_exp_f32 v92, v92
    v_fma_f32 v90, v90, v229, v229
    s_waitcnt lgkmcnt(2)
    v_mfma_f32_32x32x16_bf16 v[112:127], a[192:195], v[160:163], v[112:127]
    v_rcp_f32 v89, v89
    v_mul_f32 v87, v87, v103
    v_cvt_pk_bf16_f32 v243, v86, v87
    buffer_store_dwordx4 v[240:243], v10, s[20:23], s29 offen offset:0 sc1
    v_mfma_f32_32x32x16_bf16 v[128:143], a[196:199], v[160:163], v[128:143]
    v_mul_f32 v94, v94, v228
    v_exp_f32 v93, v93
    v_fma_f32 v91, v91, v229, v229
    v_rcp_f32 v90, v90
    v_mfma_f32_32x32x16_bf16 v[112:127], a[200:203], v[164:167], v[112:127]
    v_mul_f32 v88, v88, v104
    v_mul_f32 v95, v95, v228
    v_exp_f32 v94, v94
    v_fma_f32 v92, v92, v229, v229
    v_mfma_f32_32x32x16_bf16 v[128:143], a[204:207], v[164:167], v[128:143]
    v_rcp_f32 v91, v91
    v_mul_f32 v89, v89, v105
    v_cvt_pk_bf16_f32 v244, v88, v89
    v_exp_f32 v95, v95
    s_waitcnt lgkmcnt(0)
    v_mfma_f32_32x32x16_bf16 v[112:127], a[208:211], v[168:171], v[112:127]
    v_fma_f32 v93, v93, v229, v229
    v_rcp_f32 v92, v92
    v_mul_f32 v90, v90, v106
    v_fma_f32 v94, v94, v229, v229
    v_mfma_f32_32x32x16_bf16 v[128:143], a[212:215], v[168:171], v[128:143]
    v_rcp_f32 v93, v93
    v_mul_f32 v91, v91, v107
    v_cvt_pk_bf16_f32 v245, v90, v91
    v_fma_f32 v95, v95, v229, v229
    v_mfma_f32_32x32x16_bf16 v[112:127], a[216:219], v[172:175], v[112:127]
    v_rcp_f32 v94, v94
    v_mul_f32 v92, v92, v108
    v_rcp_f32 v95, v95
    v_mul_f32 v93, v93, v109
    v_mfma_f32_32x32x16_bf16 v[128:143], a[220:223], v[172:175], v[128:143]
    v_cvt_pk_bf16_f32 v246, v92, v93
    v_mul_f32 v94, v94, v110
    v_mul_f32 v95, v95, v111
    v_cvt_pk_bf16_f32 v247, v94, v95
    buffer_store_dwordx4 v[244:247], v10, s[20:23], s29 offen offset:512 sc1
    s_add_u32 s29, s29, 114688
    s_nop 0
    v_mul_f32 v112, v112, v230
    v_mul_f32 v113, v113, v230
    v_exp_f32 v112, v112
    v_mul_f32 v114, v114, v230
    v_exp_f32 v113, v113
    v_mul_f32 v115, v115, v230
    v_exp_f32 v114, v114
    v_fma_f32 v112, v112, v231, v231
    v_mul_f32 v116, v116, v230
    v_exp_f32 v115, v115
    v_fma_f32 v113, v113, v231, v231
    v_rcp_f32 v112, v112
    v_mul_f32 v117, v117, v230
    v_exp_f32 v116, v116
    v_fma_f32 v114, v114, v231, v231
    v_rcp_f32 v113, v113
    v_mul_f32 v118, v118, v230
    v_exp_f32 v117, v117
    v_fma_f32 v115, v115, v231, v231
    v_rcp_f32 v114, v114
    v_mul_f32 v112, v112, v128
    v_mul_f32 v119, v119, v230
    v_exp_f32 v118, v118
    v_fma_f32 v116, v116, v231, v231
    v_rcp_f32 v115, v115
    v_mul_f32 v113, v113, v129
    v_cvt_pk_bf16_f32 v240, v112, v113
    v_mul_f32 v120, v120, v230
    v_exp_f32 v119, v119
    v_fma_f32 v117, v117, v231, v231
    v_rcp_f32 v116, v116
    v_mul_f32 v114, v114, v130
    v_mul_f32 v121, v121, v230
    v_exp_f32 v120, v120
    v_fma_f32 v118, v118, v231, v231
    v_rcp_f32 v117, v117
    v_mul_f32 v115, v115, v131
    v_cvt_pk_bf16_f32 v241, v114, v115
    v_mul_f32 v122, v122, v230
    v_exp_f32 v121, v121
    v_fma_f32 v119, v119, v231, v231
    v_rcp_f32 v118, v118
    v_mul_f32 v116, v116, v132
    v_mul_f32 v123, v123, v230
    v_exp_f32 v122, v122
    v_fma_f32 v120, v120, v231, v231
    v_rcp_f32 v119, v119
    v_mul_f32 v117, v117, v133
    v_cvt_pk_bf16_f32 v242, v116, v117
    v_mul_f32 v124, v124, v230
    v_exp_f32 v123, v123
    v_fma_f32 v121, v121, v231, v231
    v_rcp_f32 v120, v120
    v_mul_f32 v118, v118, v134
    v_mul_f32 v125, v125, v230
    v_exp_f32 v124, v124
    v_fma_f32 v122, v122, v231, v231
    v_rcp_f32 v121, v121
    v_mul_f32 v119, v119, v135
    v_cvt_pk_bf16_f32 v243, v118, v119
    buffer_store_dwordx4 v[240:243], v10, s[20:23], s29 offen offset:0 sc1
    v_mul_f32 v126, v126, v230
    v_exp_f32 v125, v125
    v_fma_f32 v123, v123, v231, v231
    v_rcp_f32 v122, v122
    v_mul_f32 v120, v120, v136
    v_mul_f32 v127, v127, v230
    v_exp_f32 v126, v126
    v_fma_f32 v124, v124, v231, v231
    v_rcp_f32 v123, v123
    v_mul_f32 v121, v121, v137
    v_cvt_pk_bf16_f32 v244, v120, v121
    v_exp_f32 v127, v127
    v_fma_f32 v125, v125, v231, v231
    v_rcp_f32 v124, v124
    v_mul_f32 v122, v122, v138
    v_fma_f32 v126, v126, v231, v231
    v_rcp_f32 v125, v125
    v_mul_f32 v123, v123, v139
    v_cvt_pk_bf16_f32 v245, v122, v123
    v_fma_f32 v127, v127, v231, v231
    v_rcp_f32 v126, v126
    v_mul_f32 v124, v124, v140
    v_rcp_f32 v127, v127
    v_mul_f32 v125, v125, v141
    v_cvt_pk_bf16_f32 v246, v124, v125
    v_mul_f32 v126, v126, v142
    v_mul_f32 v127, v127, v143
    v_cvt_pk_bf16_f32 v247, v126, v127
    buffer_store_dwordx4 v[244:247], v10, s[20:23], s29 offen offset:512 sc1
    s_add_u32 s29, s29, 114688
    s_lshl_b32 s34, s58, 7
    s_add_u32 s34, s34, 2048
    s_lshl_b32 s33, s59, 2
    s_add_u32 s33, s33, s34
    v_mov_b32 v12, s96
    v_mov_b32 v13, 0
    s_waitcnt vmcnt(0)
    s_barrier
    s_cmp_lg_u32 s3, 0
    s_cbranch_scc1 K4_NOFLAG
    buffer_store_dword v12, v13, s[52:55], s33 offen sc1
K4_NOFLAG:
    s_add_u32 s47, s31, 10
    s_cmp_ge_u32 s47, 14
    s_cselect_b32 s26, 14, 0
    s_sub_u32 s47, s47, s26
    s_lshl_b32 s47, s47, 12
    s_add_u32 s47, s47, s46
    buffer_load_dwordx4 a[160:163], v4, s[16:19], s47 offen offset:0 sc1
    buffer_load_dwordx4 a[164:167], v4, s[16:19], s47 offen offset:1024 sc1
    buffer_load_dwordx4 a[168:171], v4, s[16:19], s47 offen offset:2048 sc1
    buffer_load_dwordx4 a[172:175], v4, s[16:19], s47 offen offset:3072 sc1
    s_add_u32 s47, s31, 11
    s_cmp_ge_u32 s47, 14
    s_cselect_b32 s26, 14, 0
    s_sub_u32 s47, s47, s26
    s_lshl_b32 s47, s47, 12
    s_add_u32 s47, s47, s46
    buffer_load_dwordx4 a[176:179], v4, s[16:19], s47 offen offset:0 sc1
    buffer_load_dwordx4 a[180:183], v4, s[16:19], s47 offen offset:1024 sc1
    buffer_load_dwordx4 a[184:187], v4, s[16:19], s47 offen offset:2048 sc1
    buffer_load_dwordx4 a[188:191], v4, s[16:19], s47 offen offset:3072 sc1
    s_add_u32 s47, s31, 12
    s_cmp_ge_u32 s47, 14
    s_cselect_b32 s26, 14, 0
    s_sub_u32 s47, s47, s26
    s_lshl_b32 s47, s47, 12
    s_add_u32 s47, s47, s46
    buffer_load_dwordx4 a[192:195], v4, s[16:19], s47 offen offset:0 sc1
    buffer_load_dwordx4 a[196:199], v4, s[16:19], s47 offen offset:1024 sc1
    buffer_load_dwordx4 a[200:203], v4, s[16:19], s47 offen offset:2048 sc1
    buffer_load_dwordx4 a[204:207], v4, s[16:19], s47 offen offset:3072 sc1
    s_add_u32 s47, s31, 13
    s_cmp_ge_u32 s47, 14
    s_cselect_b32 s26, 14, 0
    s_sub_u32 s47, s47, s26
    s_lshl_b32 s47, s47, 12
    s_add_u32 s47, s47, s46
    buffer_load_dwordx4 a[208:211], v4, s[16:19], s47 offen offset:0 sc1
    buffer_load_dwordx4 a[212:215], v4, s[16:19], s47 offen offset:1024 sc1
    buffer_load_dwordx4 a[216:219], v4, s[16:19], s47 offen offset:2048 sc1
    buffer_load_dwordx4 a[220:223], v4, s[16:19], s47 offen offset:3072 sc1
    s_lshr_b32 s34, s44, 1
    s_lshl_b32 s34, s34, 7
    s_add_u32 s34, s34, 2048
    s_mul_i32 s33, s3, 14
    s_lshr_b32 s33, s33, 2
    s_lshl_b32 s33, s33, 2
    s_add_u32 s34, s34, s33
    s_mul_i32 s10, s3, 14
    s_mul_i32 s28, s44, 224
    s_add_u32 s28, s28, s10
    s_lshl_b32 s28, s28, 10
    s_mov_b32 s35, s28
    s_xor_b32 s36, s3, 0
    s_mul_i32 s37, s36, 57344
    s_add_u32 s48, s35, s37
    s_xor_b32 s36, s3, 1
    s_mul_i32 s37, s36, 57344
    s_add_u32 s49, s35, s37
    s_mul_i32 s37, s36, 12288
    v_add_u32 v9, s37, v4
    s_xor_b32 s36, s3, 2
    s_mul_i32 s37, s36, 57344
    s_add_u32 s50, s35, s37
    s_mul_i32 s37, s36, 12288
    v_add_u32 v10, s37, v4
    s_xor_b32 s36, s3, 3
    s_mul_i32 s37, s36, 57344
    s_add_u32 s51, s35, s37
    s_mul_i32 s37, s36, 12288
    v_add_u32 v11, s37, v4
    s_add_u32 s12, s6, 4194304
    s_addc_u32 s13, s7, 0
    s_mov_b32 s14, 1835008
    s_mov_b32 s15, 0x00020000
    s_mov_b32 s24, s56
    s_mov_b32 s25, s57
    s_mov_b32 s26, 1835008
    s_mov_b32 s27, 0x00020000
    s_lshl_b32 s33, s44, 2
    s_add_u32 s33, s33, s3
    s_mul_i32 s35, s33, 14
    s_lshl_b32 s36, s45, 1
    s_add_u32 s35, s35, s36
    s_lshl_b32 s35, s35, 10
    s_mul_i32 s36, s3, 12288
    v_add_u32 v6, s36, v4
    v_mul_u32_u24 v7, 57344, v2
    v_lshl_add_u32 v7, v3, 4, v7
    s_and_b32 s36, s33, 1
    s_mul_i32 s36, s36, 917504
    s_lshr_b32 s37, s33, 1
    s_mul_i32 s37, s37, 896
    s_add_u32 s36, s36, s37
    s_lshl_b32 s37, s45, 7
    s_add_u32 s36, s36, s37
    v_min_u32 v13, 3, v2
    v_lshlrev_b32 v13, 2, v13
    s_mov_b32 s63, 0
E4_LOOP:
    buffer_load_dword v12, v13, s[52:55], s34 offen sc1
    s_add_u32 s63, s63, 1
    s_waitcnt vmcnt(0)
    v_cmp_ne_u32 vcc, s96, v12
    s_nop 4
    s_cmp_eq_u64 vcc, 0
    s_cbranch_scc1 E4_DONE
    s_sleep 1
    s_cmp_lt_u32 s63, 0x40000
    s_cbranch_scc1 E4_LOOP
E4_DONE:
    s_add_u32 s29, s31, 0
    s_cmp_ge_u32 s29, 14
    s_cselect_b32 s30, 14, 0
    s_sub_u32 s29, s29, s30
    s_lshl_b32 s29, s29, 10
    s_add_u32 s28, s48, s29
    buffer_load_dwordx4 v[80:83], v4, s[20:23], s28 offen sc1
    s_add_u32 s28, s49, s29
    buffer_load_dwordx4 v[84:87], v4, s[20:23], s28 offen sc1
    s_add_u32 s28, s50, s29
    buffer_load_dwordx4 v[88:91], v4, s[20:23], s28 offen sc1
    s_add_u32 s28, s51, s29
    buffer_load_dwordx4 v[92:95], v4, s[20:23], s28 offen sc1
    s_add_u32 s29, s31, 1
    s_cmp_ge_u32 s29, 14
    s_cselect_b32 s30, 14, 0
    s_sub_u32 s29, s29, s30
    s_lshl_b32 s29, s29, 10
    s_add_u32 s28, s48, s29
    buffer_load_dwordx4 v[96:99], v4, s[20:23], s28 offen sc1
    s_add_u32 s28, s49, s29
    buffer_load_dwordx4 v[100:103], v4, s[20:23], s28 offen sc1
    s_add_u32 s28, s50, s29
    buffer_load_dwordx4 v[104:107], v4, s[20:23], s28 offen sc1
    s_add_u32 s28, s51, s29
    buffer_load_dwordx4 v[108:111], v4, s[20:23], s28 offen sc1
    s_add_u32 s29, s31, 2
    s_cmp_ge_u32 s29, 14
    s_cselect_b32 s30, 14, 0
    s_sub_u32 s29, s29, s30
    s_lshl_b32 s29, s29, 10
    s_add_u32 s28, s48, s29
    buffer_load_dwordx4 v[112:115], v4, s[20:23], s28 offen sc1
    s_add_u32 s28, s49, s29
    buffer_load_dwordx4 v[116:119], v4, s[20:23], s28 offen sc1
    s_add_u32 s28, s50, s29
    buffer_load_dwordx4 v[120:123], v4, s[20:23], s28 offen sc1
    s_add_u32 s28, s51, s29
    buffer_load_dwordx4 v[124:127], v4, s[20:23], s28 offen sc1
    s_waitcnt vmcnt(8)
    v_mfma_f32_16x16x32_bf16 v[16:19], a[0:3], v[80:83], 0
    v_mfma_f32_16x16x32_bf16 v[20:23], a[4:7], v[80:83], 0
    s_add_u32 s29, s31, 3
    s_cmp_ge_u32 s29, 14
    s_cselect_b32 s30, 14, 0
    s_sub_u32 s29, s29, s30
    s_lshl_b32 s29, s29, 10
    s_add_u32 s28, s48, s29
    buffer_load_dwordx4 v[128:131], v4, s[20:23], s28 offen sc1
    v_mfma_f32_16x16x32_bf16 v[24:27], a[8:11], v[80:83], 0
    v_mfma_f32_16x16x32_bf16 v[28:31], a[12:15], v[80:83], 0
    s_add_u32 s28, s49, s29
    buffer_load_dwordx4 v[132:135], v4, s[20:23], s28 offen sc1
    v_mfma_f32_16x16x32_bf16 v[32:35], a[0:3], v[84:87], 0
    v_mfma_f32_16x16x32_bf16 v[36:39], a[4:7], v[84:87], 0
    s_add_u32 s28, s50, s29
    buffer_load_dwordx4 v[136:139], v4, s[20:23], s28 offen sc1
    v_mfma_f32_16x16x32_bf16 v[40:43], a[8:11], v[84:87], 0
    v_mfma_f32_16x16x32_bf16 v[44:47], a[12:15], v[84:87], 0
    s_add_u32 s28, s51, s29
    buffer_load_dwordx4 v[140:143], v4, s[20:23], s28 offen sc1
    v_mfma_f32_16x16x32_bf16 v[48:51], a[0:3], v[88:91], 0
    v_mfma_f32_16x16x32_bf16 v[52:55], a[4:7], v[88:91], 0
    s_add_u32 s29, s31, 4
    s_cmp_ge_u32 s29, 14
    s_cselect_b32 s30, 14, 0
    s_sub_u32 s29, s29, s30
    s_lshl_b32 s29, s29, 10
    s_add_u32 s28, s48, s29
    buffer_load_dwordx4 v[144:147], v4, s[20:23], s28 offen sc1
    v_mfma_f32_16x16x32_bf16 v[56:59], a[8:11], v[88:91], 0
    v_mfma_f32_16x16x32_bf16 v[60:63], a[12:15], v[88:91], 0
    s_add_u32 s28, s49, s29
    buffer_load_dwordx4 v[148:151], v4, s[20:23], s28 offen sc1
    v_mfma_f32_16x16x32_bf16 v[64:67], a[0:3], v[92:95], 0
    v_mfma_f32_16x16x32_bf16 v[68:71], a[4:7], v[92:95], 0
    s_add_u32 s28, s50, s29
    buffer_load_dwordx4 v[152:155], v4, s[20:23], s28 offen sc1
    v_mfma_f32_16x16x32_bf16 v[72:75], a[8:11], v[92:95], 0
    v_mfma_f32_16x16x32_bf16 v[76:79], a[12:15], v[92:95], 0
    s_add_u32 s28, s51, s29
    buffer_load_dwordx4 v[156:159], v4, s[20:23], s28 offen sc1
    s_waitcnt vmcnt(12)
    v_mfma_f32_16x16x32_bf16 v[16:19], a[16:19], v[96:99], v[16:19]
    v_mfma_f32_16x16x32_bf16 v[20:23], a[20:23], v[96:99], v[20:23]
    s_add_u32 s29, s31, 5
    s_cmp_ge_u32 s29, 14
    s_cselect_b32 s30, 14, 0
    s_sub_u32 s29, s29, s30
    s_lshl_b32 s29, s29, 10
    s_add_u32 s28, s48, s29
    buffer_load_dwordx4 v[160:163], v4, s[20:23], s28 offen sc1
    v_mfma_f32_16x16x32_bf16 v[24:27], a[24:27], v[96:99], v[24:27]
    v_mfma_f32_16x16x32_bf16 v[28:31], a[28:31], v[96:99], v[28:31]
    s_add_u32 s28, s49, s29
    buffer_load_dwordx4 v[164:167], v4, s[20:23], s28 offen sc1
    v_mfma_f32_16x16x32_bf16 v[32:35], a[16:19], v[100:103], v[32:35]
    v_mfma_f32_16x16x32_bf16 v[36:39], a[20:23], v[100:103], v[36:39]
    s_add_u32 s28, s50, s29
    buffer_load_dwordx4 v[168:171], v4, s[20:23], s28 offen sc1
    v_mfma_f32_16x16x32_bf16 v[40:43], a[24:27], v[100:103], v[40:43]
    v_mfma_f32_16x16x32_bf16 v[44:47], a[28:31], v[100:103], v[44:47]
    s_add_u32 s28, s51, s29
    buffer_load_dwordx4 v[172:175], v4, s[20:23], s28 offen sc1
    v_mfma_f32_16x16x32_bf16 v[48:51], a[16:19], v[104:107], v[48:51]
    v_mfma_f32_16x16x32_bf16 v[52:55], a[20:23], v[104:107], v[52:55]
    s_add_u32 s29, s31, 6
    s_cmp_ge_u32 s29, 14
    s_cselect_b32 s30, 14, 0
    s_sub_u32 s29, s29, s30
    s_lshl_b32 s29, s29, 10
    s_add_u32 s28, s48, s29
    buffer_load_dwordx4 v[176:179], v4, s[20:23], s28 offen sc1
    v_mfma_f32_16x16x32_bf16 v[56:59], a[24:27], v[104:107], v[56:59]
    v_mfma_f32_16x16x32_bf16 v[60:63], a[28:31], v[104:107], v[60:63]
    s_add_u32 s28, s49, s29
    buffer_load_dwordx4 v[180:183], v4, s[20:23], s28 offen sc1
    v_mfma_f32_16x16x32_bf16 v[64:67], a[16:19], v[108:111], v[64:67]
    v_mfma_f32_16x16x32_bf16 v[68:71], a[20:23], v[108:111], v[68:71]
    s_add_u32 s28, s50, s29
    buffer_load_dwordx4 v[184:187], v4, s[20:23], s28 offen sc1
    v_mfma_f32_16x16x32_bf16 v[72:75], a[24:27], v[108:111], v[72:75]
    v_mfma_f32_16x16x32_bf16 v[76:79], a[28:31], v[108:111], v[76:79]
    s_add_u32 s28, s51, s29
    buffer_load_dwordx4 v[188:191], v4, s[20:23], s28 offen sc1
    s_waitcnt vmcnt(16)
    v_mfma_f32_16x16x32_bf16 v[16:19], a[32:35], v[112:115], v[16:19]
    v_mfma_f32_16x16x32_bf16 v[20:23], a[36:39], v[112:115], v[20:23]
    s_add_u32 s29, s31, 7
    s_cmp_ge_u32 s29, 14
    s_cselect_b32 s30, 14, 0
    s_sub_u32 s29, s29, s30
    s_lshl_b32 s29, s29, 10
    s_add_u32 s28, s48, s29
    buffer_load_dwordx4 v[192:195], v4, s[20:23], s28 offen sc1
    v_mfma_f32_16x16x32_bf16 v[24:27], a[40:43], v[112:115], v[24:27]
    v_mfma_f32_16x16x32_bf16 v[28:31], a[44:47], v[112:115], v[28:31]
    s_add_u32 s28, s49, s29
    buffer_load_dwordx4 v[196:199], v4, s[20:23], s28 offen sc1
    v_mfma_f32_16x16x32_bf16 v[32:35], a[32:35], v[116:119], v[32:35]
    v_mfma_f32_16x16x32_bf16 v[36:39], a[36:39], v[116:119], v[36:39]
    s_add_u32 s28, s50, s29
    buffer_load_dwordx4 v[200:203], v4, s[20:23], s28 offen sc1
    v_mfma_f32_16x16x32_bf16 v[40:43], a[40:43], v[116:119], v[40:43]
    v_mfma_f32_16x16x32_bf16 v[44:47], a[44:47], v[116:119], v[44:47]
    s_add_u32 s28, s51, s29
    buffer_load_dwordx4 v[204:207], v4, s[20:23], s28 offen sc1
    v_mfma_f32_16x16x32_bf16 v[48:51], a[32:35], v[120:123], v[48:51]
    v_mfma_f32_16x16x32_bf16 v[52:55], a[36:39], v[120:123], v[52:55]
    s_add_u32 s29, s31, 8
    s_cmp_ge_u32 s29, 14
    s_cselect_b32 s30, 14, 0
    s_sub_u32 s29, s29, s30
    s_lshl_b32 s29, s29, 10
    s_add_u32 s28, s48, s29
    buffer_load_dwordx4 v[208:211], v4, s[20:23], s28 offen sc1
    v_mfma_f32_16x16x32_bf16 v[56:59], a[40:43], v[120:123], v[56:59]
    v_mfma_f32_16x16x32_bf16 v[60:63], a[44:47], v[120:123], v[60:63]
    s_add_u32 s28, s49, s29
    buffer_load_dwordx4 v[212:215], v4, s[20:23], s28 offen sc1
    v_mfma_f32_16x16x32_bf16 v[64:67], a[32:35], v[124:127], v[64:67]
    v_mfma_f32_16x16x32_bf16 v[68:71], a[36:39], v[124:127], v[68:71]
    s_add_u32 s28, s50, s29
    buffer_load_dwordx4 v[216:219], v4, s[20:23], s28 offen sc1
    v_mfma_f32_16x16x32_bf16 v[72:75], a[40:43], v[124:127], v[72:75]
    v_mfma_f32_16x16x32_bf16 v[76:79], a[44:47], v[124:127], v[76:79]
    s_add_u32 s28, s51, s29
    buffer_load_dwordx4 v[220:223], v4, s[20:23], s28 offen sc1
    s_waitcnt vmcnt(20)
    v_mfma_f32_16x16x32_bf16 v[16:19], a[48:51], v[128:131], v[16:19]
    v_mfma_f32_16x16x32_bf16 v[20:23], a[52:55], v[128:131], v[20:23]
    s_add_u32 s29, s31, 9
    s_cmp_ge_u32 s29, 14
    s_cselect_b32 s30, 14, 0
    s_sub_u32 s29, s29, s30
    s_lshl_b32 s29, s29, 10
    s_add_u32 s28, s48, s29
    buffer_load_dwordx4 v[224:227], v4, s[20:23], s28 offen sc1
    v_mfma_f32_16x16x32_bf16 v[24:27], a[56:59], v[128:131], v[24:27]
    v_mfma_f32_16x16x32_bf16 v[28:31], a[60:63], v[128:131], v[28:31]
    s_add_u32 s28, s49, s29
    buffer_load_dwordx4 v[228:231], v4, s[20:23], s28 offen sc1
    v_mfma_f32_16x16x32_bf16 v[32:35], a[48:51], v[132:135], v[32:35]
    v_mfma_f32_16x16x32_bf16 v[36:39], a[52:55], v[132:135], v[36:39]
    s_add_u32 s28, s50, s29
    buffer_load_dwordx4 v[232:235], v4, s[20:23], s28 offen sc1
    v_mfma_f32_16x16x32_bf16 v[40:43], a[56:59], v[132:135], v[40:43]
    v_mfma_f32_16x16x32_bf16 v[44:47], a[60:63], v[132:135], v[44:47]
    s_add_u32 s28, s51, s29
    buffer_load_dwordx4 v[236:239], v4, s[20:23], s28 offen sc1
    v_mfma_f32_16x16x32_bf16 v[48:51], a[48:51], v[136:139], v[48:51]
    v_mfma_f32_16x16x32_bf16 v[52:55], a[52:55], v[136:139], v[52:55]
    s_add_u32 s29, s31, 10
    s_cmp_ge_u32 s29, 14
    s_cselect_b32 s30, 14, 0
    s_sub_u32 s29, s29, s30
    s_lshl_b32 s29, s29, 10
    s_add_u32 s28, s48, s29
    buffer_load_dwordx4 v[80:83], v4, s[20:23], s28 offen sc1
    v_mfma_f32_16x16x32_bf16 v[56:59], a[56:59], v[136:139], v[56:59]
    v_mfma_f32_16x16x32_bf16 v[60:63], a[60:63], v[136:139], v[60:63]
    s_add_u32 s28, s49, s29
    buffer_load_dwordx4 v[84:87], v4, s[20:23], s28 offen sc1
    v_mfma_f32_16x16x32_bf16 v[64:67], a[48:51], v[140:143], v[64:67]
    v_mfma_f32_16x16x32_bf16 v[68:71], a[52:55], v[140:143], v[68:71]
    s_add_u32 s28, s50, s29
    buffer_load_dwordx4 v[88:91], v4, s[20:23], s28 offen sc1
    v_mfma_f32_16x16x32_bf16 v[72:75], a[56:59], v[140:143], v[72:75]
    v_mfma_f32_16x16x32_bf16 v[76:79], a[60:63], v[140:143], v[76:79]
    s_add_u32 s28, s51, s29
    buffer_load_dwordx4 v[92:95], v4, s[20:23], s28 offen sc1
    s_waitcnt vmcnt(24)
    v_mfma_f32_16x16x32_bf16 v[16:19], a[64:67], v[144:147], v[16:19]
    v_mfma_f32_16x16x32_bf16 v[20:23], a[68:71], v[144:147], v[20:23]
    s_add_u32 s29, s31, 11
    s_cmp_ge_u32 s29, 14
    s_cselect_b32 s30, 14, 0
    s_sub_u32 s29, s29, s30
    s_lshl_b32 s29, s29, 10
    s_add_u32 s28, s48, s29
    buffer_load_dwordx4 v[96:99], v4, s[20:23], s28 offen sc1
    v_mfma_f32_16x16x32_bf16 v[24:27], a[72:75], v[144:147], v[24:27]
    v_mfma_f32_16x16x32_bf16 v[28:31], a[76:79], v[144:147], v[28:31]
    s_add_u32 s28, s49, s29
    buffer_load_dwordx4 v[100:103], v4, s[20:23], s28 offen sc1
    v_mfma_f32_16x16x32_bf16 v[32:35], a[64:67], v[148:151], v[32:35]
    v_mfma_f32_16x16x32_bf16 v[36:39], a[68:71], v[148:151], v[36:39]
    s_add_u32 s28, s50, s29
    buffer_load_dwordx4 v[104:107], v4, s[20:23], s28 offen sc1
    v_mfma_f32_16x16x32_bf16 v[40:43], a[72:75], v[148:151], v[40:43]
    v_mfma_f32_16x16x32_bf16 v[44:47], a[76:79], v[148:151], v[44:47]
    s_add_u32 s28, s51, s29
    buffer_load_dwordx4 v[108:111], v4, s[20:23], s28 offen sc1
    v_mfma_f32_16x16x32_bf16 v[48:51], a[64:67], v[152:155], v[48:51]
    v_mfma_f32_16x16x32_bf16 v[52:55], a[68:71], v[152:155], v[52:55]
    s_add_u32 s29, s31, 12
    s_cmp_ge_u32 s29, 14
    s_cselect_b32 s30, 14, 0
    s_sub_u32 s29, s29, s30
    s_lshl_b32 s29, s29, 10
    s_add_u32 s28, s48, s29
    buffer_load_dwordx4 v[112:115], v4, s[20:23], s28 offen sc1
    v_mfma_f32_16x16x32_bf16 v[56:59], a[72:75], v[152:155], v[56:59]
    v_mfma_f32_16x16x32_bf16 v[60:63], a[76:79], v[152:155], v[60:63]
    s_add_u32 s28, s49, s29
    buffer_load_dwordx4 v[116:119], v4, s[20:23], s28 offen sc1
    v_mfma_f32_16x16x32_bf16 v[64:67], a[64:67], v[156:159], v[64:67]
    v_mfma_f32_16x16x32_bf16 v[68:71], a[68:71], v[156:159], v[68:71]
    s_add_u32 s28, s50, s29
    buffer_load_dwordx4 v[120:123], v4, s[20:23], s28 offen sc1
    v_mfma_f32_16x16x32_bf16 v[72:75], a[72:75], v[156:159], v[72:75]
    v_mfma_f32_16x16x32_bf16 v[76:79], a[76:79], v[156:159], v[76:79]
    s_add_u32 s28, s51, s29
    buffer_load_dwordx4 v[124:127], v4, s[20:23], s28 offen sc1
    s_waitcnt vmcnt(28)
    v_mfma_f32_16x16x32_bf16 v[16:19], a[80:83], v[160:163], v[16:19]
    v_mfma_f32_16x16x32_bf16 v[20:23], a[84:87], v[160:163], v[20:23]
    s_add_u32 s29, s31, 13
    s_cmp_ge_u32 s29, 14
    s_cselect_b32 s30, 14, 0
    s_sub_u32 s29, s29, s30
    s_lshl_b32 s29, s29, 10
    s_add_u32 s28, s48, s29
    buffer_load_dwordx4 v[128:131], v4, s[20:23], s28 offen sc1
    v_mfma_f32_16x16x32_bf16 v[24:27], a[88:91], v[160:163], v[24:27]
    v_mfma_f32_16x16x32_bf16 v[28:31], a[92:95], v[160:163], v[28:31]
    s_add_u32 s28, s49, s29
    buffer_load_dwordx4 v[132:135], v4, s[20:23], s28 offen sc1
    v_mfma_f32_16x16x32_bf16 v[32:35], a[80:83], v[164:167], v[32:35]
    v_mfma_f32_16x16x32_bf16 v[36:39], a[84:87], v[164:167], v[36:39]
    s_add_u32 s28, s50, s29
    buffer_load_dwordx4 v[136:139], v4, s[20:23], s28 offen sc1
    v_mfma_f32_16x16x32_bf16 v[40:43], a[88:91], v[164:167], v[40:43]
    v_mfma_f32_16x16x32_bf16 v[44:47], a[92:95], v[164:167], v[44:47]
    s_add_u32 s28, s51, s29
    buffer_load_dwordx4 v[140:143], v4, s[20:23], s28 offen sc1
    v_mfma_f32_16x16x32_bf16 v[48:51], a[80:83], v[168:171], v[48:51]
    v_mfma_f32_16x16x32_bf16 v[52:55], a[84:87], v[168:171], v[52:55]
    v_mfma_f32_16x16x32_bf16 v[56:59], a[88:91], v[168:171], v[56:59]
    v_mfma_f32_16x16x32_bf16 v[60:63], a[92:95], v[168:171], v[60:63]
    v_mfma_f32_16x16x32_bf16 v[64:67], a[80:83], v[172:175], v[64:67]
    v_mfma_f32_16x16x32_bf16 v[68:71], a[84:87], v[172:175], v[68:71]
    v_mfma_f32_16x16x32_bf16 v[72:75], a[88:91], v[172:175], v[72:75]
    v_mfma_f32_16x16x32_bf16 v[76:79], a[92:95], v[172:175], v[76:79]
    s_waitcnt vmcnt(28)
    v_mfma_f32_16x16x32_bf16 v[16:19], a[96:99], v[176:179], v[16:19]
    v_mfma_f32_16x16x32_bf16 v[20:23], a[100:103], v[176:179], v[20:23]
    v_mfma_f32_16x16x32_bf16 v[24:27], a[104:107], v[176:179], v[24:27]
    v_mfma_f32_16x16x32_bf16 v[28:31], a[108:111], v[176:179], v[28:31]
    v_mfma_f32_16x16x32_bf16 v[32:35], a[96:99], v[180:183], v[32:35]
    v_mfma_f32_16x16x32_bf16 v[36:39], a[100:103], v[180:183], v[36:39]
    v_mfma_f32_16x16x32_bf16 v[40:43], a[104:107], v[180:183], v[40:43]
    v_mfma_f32_16x16x32_bf16 v[44:47], a[108:111], v[180:183], v[44:47]
    v_mfma_f32_16x16x32_bf16 v[48:51], a[96:99], v[184:187], v[48:51]
    v_mfma_f32_16x16x32_bf16 v[52:55], a[100:103], v[184:187], v[52:55]
    v_mfma_f32_16x16x32_bf16 v[56:59], a[104:107], v[184:187], v[56:59]
    v_mfma_f32_16x16x32_bf16 v[60:63], a[108:111], v[184:187], v[60:63]
    v_mfma_f32_16x16x32_bf16 v[64:67], a[96:99], v[188:191], v[64:67]
    v_mfma_f32_16x16x32_bf16 v[68:71], a[100:103], v[188:191], v[68:71]
    v_mfma_f32_16x16x32_bf16 v[72:75], a[104:107], v[188:191], v[72:75]
    v_mfma_f32_16x16x32_bf16 v[76:79], a[108:111], v[188:191], v[76:79]
    buffer_load_dwordx4 v[240:243], v4, s[12:15], s35 offen sc1
    buffer_load_dwordx4 v[244:247], v4, s[12:15], s35 offen offset:1024 sc1
    s_waitcnt vmcnt(26)
    v_mfma_f32_16x16x32_bf16 v[16:19], a[112:115], v[192:195], v[16:19]
    v_mfma_f32_16x16x32_bf16 v[20:23], a[116:119], v[192:195], v[20:23]
    v_mfma_f32_16x16x32_bf16 v[24:27], a[120:123], v[192:195], v[24:27]
    v_mfma_f32_16x16x32_bf16 v[28:31], a[124:127], v[192:195], v[28:31]
    v_mfma_f32_16x16x32_bf16 v[32:35], a[112:115], v[196:199], v[32:35]
    v_mfma_f32_16x16x32_bf16 v[36:39], a[116:119], v[196:199], v[36:39]
    v_mfma_f32_16x16x32_bf16 v[40:43], a[120:123], v[196:199], v[40:43]
    v_mfma_f32_16x16x32_bf16 v[44:47], a[124:127], v[196:199], v[44:47]
    v_mfma_f32_16x16x32_bf16 v[48:51], a[112:115], v[200:203], v[48:51]
    v_mfma_f32_16x16x32_bf16 v[52:55], a[116:119], v[200:203], v[52:55]
    v_mfma_f32_16x16x32_bf16 v[56:59], a[120:123], v[200:203], v[56:59]
    v_mfma_f32_16x16x32_bf16 v[60:63], a[124:127], v[200:203], v[60:63]
    v_mfma_f32_16x16x32_bf16 v[64:67], a[112:115], v[204:207], v[64:67]
    v_mfma_f32_16x16x32_bf16 v[68:71], a[116:119], v[204:207], v[68:71]
    v_mfma_f32_16x16x32_bf16 v[72:75], a[120:123], v[204:207], v[72:75]
    v_mfma_f32_16x16x32_bf16 v[76:79], a[124:127], v[204:207], v[76:79]
    s_waitcnt vmcnt(22)
    v_mfma_f32_16x16x32_bf16 v[16:19], a[224:227], v[208:211], v[16:19]
    v_mfma_f32_16x16x32_bf16 v[20:23], a[228:231], v[208:211], v[20:23]
    v_mfma_f32_16x16x32_bf16 v[24:27], a[232:235], v[208:211], v[24:27]
    v_mfma_f32_16x16x32_bf16 v[28:31], a[236:239], v[208:211], v[28:31]
    v_mfma_f32_16x16x32_bf16 v[32:35], a[224:227], v[212:215], v[32:35]
    v_mfma_f32_16x16x32_bf16 v[36:39], a[228:231], v[212:215], v[36:39]
    v_mfma_f32_16x16x32_bf16 v[40:43], a[232:235], v[212:215], v[40:43]
    v_mfma_f32_16x16x32_bf16 v[44:47], a[236:239], v[212:215], v[44:47]
    v_mfma_f32_16x16x32_bf16 v[48:51], a[224:227], v[216:219], v[48:51]
    v_mfma_f32_16x16x32_bf16 v[52:55], a[228:231], v[216:219], v[52:55]
    v_mfma_f32_16x16x32_bf16 v[56:59], a[232:235], v[216:219], v[56:59]
    v_mfma_f32_16x16x32_bf16 v[60:63], a[236:239], v[216:219], v[60:63]
    v_mfma_f32_16x16x32_bf16 v[64:67], a[224:227], v[220:223], v[64:67]
    v_mfma_f32_16x16x32_bf16 v[68:71], a[228:231], v[220:223], v[68:71]
    v_mfma_f32_16x16x32_bf16 v[72:75], a[232:235], v[220:223], v[72:75]
    v_mfma_f32_16x16x32_bf16 v[76:79], a[236:239], v[220:223], v[76:79]
    s_waitcnt vmcnt(18)
    v_mfma_f32_16x16x32_bf16 v[16:19], a[240:243], v[224:227], v[16:19]
    v_mfma_f32_16x16x32_bf16 v[20:23], a[244:247], v[224:227], v[20:23]
    v_mfma_f32_16x16x32_bf16 v[24:27], a[248:251], v[224:227], v[24:27]
    v_mfma_f32_16x16x32_bf16 v[28:31], a[252:255], v[224:227], v[28:31]
    v_mfma_f32_16x16x32_bf16 v[32:35], a[240:243], v[228:231], v[32:35]
    v_mfma_f32_16x16x32_bf16 v[36:39], a[244:247], v[228:231], v[36:39]
    v_mfma_f32_16x16x32_bf16 v[40:43], a[248:251], v[228:231], v[40:43]
    v_mfma_f32_16x16x32_bf16 v[44:47], a[252:255], v[228:231], v[44:47]
    v_mfma_f32_16x16x32_bf16 v[48:51], a[240:243], v[232:235], v[48:51]
    v_mfma_f32_16x16x32_bf16 v[52:55], a[244:247], v[232:235], v[52:55]
    v_mfma_f32_16x16x32_bf16 v[56:59], a[248:251], v[232:235], v[56:59]
    v_mfma_f32_16x16x32_bf16 v[60:63], a[252:255], v[232:235], v[60:63]
    v_mfma_f32_16x16x32_bf16 v[64:67], a[240:243], v[236:239], v[64:67]
    v_mfma_f32_16x16x32_bf16 v[68:71], a[244:247], v[236:239], v[68:71]
    v_mfma_f32_16x16x32_bf16 v[72:75], a[248:251], v[236:239], v[72:75]
    v_mfma_f32_16x16x32_bf16 v[76:79], a[252:255], v[236:239], v[76:79]
    s_waitcnt vmcnt(14)
    v_mfma_f32_16x16x32_bf16 v[16:19], a[160:163], v[80:83], v[16:19]
    v_mfma_f32_16x16x32_bf16 v[20:23], a[164:167], v[80:83], v[20:23]
    v_mfma_f32_16x16x32_bf16 v[24:27], a[168:171], v[80:83], v[24:27]
    v_mfma_f32_16x16x32_bf16 v[28:31], a[172:175], v[80:83], v[28:31]
    v_mfma_f32_16x16x32_bf16 v[32:35], a[160:163], v[84:87], v[32:35]
    v_mfma_f32_16x16x32_bf16 v[36:39], a[164:167], v[84:87], v[36:39]
    v_mfma_f32_16x16x32_bf16 v[40:43], a[168:171], v[84:87], v[40:43]
    v_mfma_f32_16x16x32_bf16 v[44:47], a[172:175], v[84:87], v[44:47]
    v_mfma_f32_16x16x32_bf16 v[48:51], a[160:163], v[88:91], v[48:51]
    v_mfma_f32_16x16x32_bf16 v[52:55], a[164:167], v[88:91], v[52:55]
    v_mfma_f32_16x16x32_bf16 v[56:59], a[168:171], v[88:91], v[56:59]
    v_mfma_f32_16x16x32_bf16 v[60:63], a[172:175], v[88:91], v[60:63]
    v_mfma_f32_16x16x32_bf16 v[64:67], a[160:163], v[92:95], v[64:67]
    v_mfma_f32_16x16x32_bf16 v[68:71], a[164:167], v[92:95], v[68:71]
    v_mfma_f32_16x16x32_bf16 v[72:75], a[168:171], v[92:95], v[72:75]
    v_mfma_f32_16x16x32_bf16 v[76:79], a[172:175], v[92:95], v[76:79]
    s_waitcnt vmcnt(10)
    v_mfma_f32_16x16x32_bf16 v[16:19], a[176:179], v[96:99], v[16:19]
    v_mfma_f32_16x16x32_bf16 v[20:23], a[180:183], v[96:99], v[20:23]
    v_mfma_f32_16x16x32_bf16 v[24:27], a[184:187], v[96:99], v[24:27]
    v_mfma_f32_16x16x32_bf16 v[28:31], a[188:191], v[96:99], v[28:31]
    v_mfma_f32_16x16x32_bf16 v[32:35], a[176:179], v[100:103], v[32:35]
    v_mfma_f32_16x16x32_bf16 v[36:39], a[180:183], v[100:103], v[36:39]
    v_mfma_f32_16x16x32_bf16 v[40:43], a[184:187], v[100:103], v[40:43]
    v_mfma_f32_16x16x32_bf16 v[44:47], a[188:191], v[100:103], v[44:47]
    v_mfma_f32_16x16x32_bf16 v[48:51], a[176:179], v[104:107], v[48:51]
    v_mfma_f32_16x16x32_bf16 v[52:55], a[180:183], v[104:107], v[52:55]
    v_mfma_f32_16x16x32_bf16 v[56:59], a[184:187], v[104:107], v[56:59]
    v_mfma_f32_16x16x32_bf16 v[60:63], a[188:191], v[104:107], v[60:63]
    v_mfma_f32_16x16x32_bf16 v[64:67], a[176:179], v[108:111], v[64:67]
    v_mfma_f32_16x16x32_bf16 v[68:71], a[180:183], v[108:111], v[68:71]
    v_mfma_f32_16x16x32_bf16 v[72:75], a[184:187], v[108:111], v[72:75]
    v_mfma_f32_16x16x32_bf16 v[76:79], a[188:191], v[108:111], v[76:79]
    s_waitcnt vmcnt(6)
    v_mfma_f32_16x16x32_bf16 v[16:19], a[192:195], v[112:115], v[16:19]
    v_mfma_f32_16x16x32_bf16 v[20:23], a[196:199], v[112:115], v[20:23]
    v_mfma_f32_16x16x32_bf16 v[24:27], a[200:203], v[112:115], v[24:27]
    v_mfma_f32_16x16x32_bf16 v[28:31], a[204:207], v[112:115], v[28:31]
    v_mfma_f32_16x16x32_bf16 v[32:35], a[192:195], v[116:119], v[32:35]
    v_mfma_f32_16x16x32_bf16 v[36:39], a[196:199], v[116:119], v[36:39]
    v_mfma_f32_16x16x32_bf16 v[40:43], a[200:203], v[116:119], v[40:43]
    v_mfma_f32_16x16x32_bf16 v[44:47], a[204:207], v[116:119], v[44:47]
    v_mfma_f32_16x16x32_bf16 v[48:51], a[192:195], v[120:123], v[48:51]
    v_mfma_f32_16x16x32_bf16 v[52:55], a[196:199], v[120:123], v[52:55]
    v_mfma_f32_16x16x32_bf16 v[56:59], a[200:203], v[120:123], v[56:59]
    v_mfma_f32_16x16x32_bf16 v[60:63], a[204:207], v[120:123], v[60:63]
    v_mfma_f32_16x16x32_bf16 v[64:67], a[192:195], v[124:127], v[64:67]
    v_mfma_f32_16x16x32_bf16 v[68:71], a[196:199], v[124:127], v[68:71]
    v_mfma_f32_16x16x32_bf16 v[72:75], a[200:203], v[124:127], v[72:75]
    v_mfma_f32_16x16x32_bf16 v[76:79], a[204:207], v[124:127], v[76:79]
    s_waitcnt vmcnt(2)
    v_mfma_f32_16x16x32_bf16 v[32:35], a[208:211], v[132:135], v[32:35]
    v_mfma_f32_16x16x32_bf16 v[36:39], a[212:215], v[132:135], v[36:39]
    v_mfma_f32_16x16x32_bf16 v[40:43], a[216:219], v[132:135], v[40:43]
    v_mfma_f32_16x16x32_bf16 v[44:47], a[220:223], v[132:135], v[44:47]
    v_mfma_f32_16x16x32_bf16 v[48:51], a[208:211], v[136:139], v[48:51]
    s_nop 3
    ds_write_b128 v9, v[32:35] offset:0
    v_mfma_f32_16x16x32_bf16 v[52:55], a[212:215], v[136:139], v[52:55]
    ds_write_b128 v9, v[36:39] offset:1024
    v_mfma_f32_16x16x32_bf16 v[56:59], a[216:219], v[136:139], v[56:59]
    ds_write_b128 v9, v[40:43] offset:2048
    v_mfma_f32_16x16x32_bf16 v[60:63], a[220:223], v[136:139], v[60:63]
    ds_write_b128 v9, v[44:47] offset:3072
    v_mfma_f32_16x16x32_bf16 v[64:67], a[208:211], v[140:143], v[64:67]
    ds_write_b128 v10, v[48:51] offset:4096
    v_mfma_f32_16x16x32_bf16 v[68:71], a[212:215], v[140:143], v[68:71]
    ds_write_b128 v10, v[52:55] offset:5120
    v_mfma_f32_16x16x32_bf16 v[72:75], a[216:219], v[140:143], v[72:75]
    ds_write_b128 v10, v[56:59] offset:6144
    v_mfma_f32_16x16x32_bf16 v[76:79], a[220:223], v[140:143], v[76:79]
    ds_write_b128 v10, v[60:63] offset:7168
    v_mfma_f32_16x16x32_bf16 v[16:19], a[208:211], v[128:131], v[16:19]
    ds_write_b128 v11, v[64:67] offset:8192
    v_mfma_f32_16x16x32_bf16 v[20:23], a[212:215], v[128:131], v[20:23]
    ds_write_b128 v11, v[68:71] offset:9216
    v_mfma_f32_16x16x32_bf16 v[24:27], a[216:219], v[128:131], v[24:27]
    ds_write_b128 v11, v[72:75] offset:10240
    v_mfma_f32_16x16x32_bf16 v[28:31], a[220:223], v[128:131], v[28:31]
    ds_write_b128 v11, v[76:79] offset:11264
    s_waitcnt lgkmcnt(0)
    s_barrier
    ds_read_b128 v[32:35], v6 offset:0
    ds_read_b128 v[36:39], v6 offset:1024
    ds_read_b128 v[40:43], v6 offset:2048
    ds_read_b128 v[44:47], v6 offset:3072
    ds_read_b128 v[48:51], v6 offset:4096
    ds_read_b128 v[52:55], v6 offset:5120
    ds_read_b128 v[56:59], v6 offset:6144
    ds_read_b128 v[60:63], v6 offset:7168
    ds_read_b128 v[64:67], v6 offset:8192
    ds_read_b128 v[68:71], v6 offset:9216
    ds_read_b128 v[72:75], v6 offset:10240
    ds_read_b128 v[76:79], v6 offset:11264
    s_waitcnt vmcnt(0)
    v_lshlrev_b32 v104, 16, v240
    v_and_b32 v105, 0xffff0000, v240
    v_lshlrev_b32 v106, 16, v241
    v_and_b32 v107, 0xffff0000, v241
    v_lshlrev_b32 v108, 16, v242
    v_and_b32 v109, 0xffff0000, v242
    v_lshlrev_b32 v110, 16, v243
    v_and_b32 v111, 0xffff0000, v243
    v_lshlrev_b32 v112, 16, v244
    v_and_b32 v113, 0xffff0000, v244
    v_lshlrev_b32 v114, 16, v245
    v_and_b32 v115, 0xffff0000, v245
    v_lshlrev_b32 v116, 16, v246
    v_and_b32 v117, 0xffff0000, v246
    v_lshlrev_b32 v118, 16, v247
    v_and_b32 v119, 0xffff0000, v247
    s_waitcnt lgkmcnt(8)
    v_add_f32 v16, v16, v32
    v_add_f32 v17, v17, v33
    v_add_f32 v18, v18, v34
    v_add_f32 v19, v19, v35
    v_add_f32 v20, v20, v36
    v_add_f32 v21, v21, v37
    v_add_f32 v22, v22, v38
    v_add_f32 v23, v23, v39
    v_add_f32 v24, v24, v40
    v_add_f32 v25, v25, v41
    v_add_f32 v26, v26, v42
    v_add_f32 v27, v27, v43
    v_add_f32 v28, v28, v44
    v_add_f32 v29, v29, v45
    v_add_f32 v30, v30, v46
    v_add_f32 v31, v31, v47
    s_waitcnt lgkmcnt(4)
    v_add_f32 v16, v16, v48
    v_add_f32 v17, v17, v49
    v_add_f32 v18, v18, v50
    v_add_f32 v19, v19, v51
    v_add_f32 v20, v20, v52
    v_add_f32 v21, v21, v53
    v_add_f32 v22, v22, v54
    v_add_f32 v23, v23, v55
    v_add_f32 v24, v24, v56
    v_add_f32 v25, v25, v57
    v_add_f32 v26, v26, v58
    v_add_f32 v27, v27, v59
    v_add_f32 v28, v28, v60
    v_add_f32 v29, v29, v61
    v_add_f32 v30, v30, v62
    v_add_f32 v31, v31, v63
    s_waitcnt lgkmcnt(0)
    v_add_f32 v16, v16, v64
    v_add_f32 v17, v17, v65
    v_add_f32 v18, v18, v66
    v_add_f32 v19, v19, v67
    v_add_f32 v20, v20, v68
    v_add_f32 v21, v21, v69
    v_add_f32 v22, v22, v70
    v_add_f32 v23, v23, v71
    v_add_f32 v24, v24, v72
    v_add_f32 v25, v25, v73
    v_add_f32 v26, v26, v74
    v_add_f32 v27, v27, v75
    v_add_f32 v28, v28, v76
    v_add_f32 v29, v29, v77
    v_add_f32 v30, v30, v78
    v_add_f32 v31, v31, v79
    v_cvt_pk_bf16_f32 v96, v16, v17
    v_cvt_pk_bf16_f32 v97, v18, v19
    v_cvt_pk_bf16_f32 v98, v20, v21
    v_cvt_pk_bf16_f32 v99, v22, v23
    v_cvt_pk_bf16_f32 v100, v24, v25
    v_cvt_pk_bf16_f32 v101, v26, v27
    v_cvt_pk_bf16_f32 v102, v28, v29
    v_cvt_pk_bf16_f32 v103, v30, v31
    v_lshlrev_b32 v16, 16, v96
    v_and_b32 v17, 0xffff0000, v96
    v_lshlrev_b32 v18, 16, v97
    v_and_b32 v19, 0xffff0000, v97
    v_lshlrev_b32 v20, 16, v98
    v_and_b32 v21, 0xffff0000, v98
    v_lshlrev_b32 v22, 16, v99
    v_and_b32 v23, 0xffff0000, v99
    v_lshlrev_b32 v24, 16, v100
    v_and_b32 v25, 0xffff0000, v100
    v_lshlrev_b32 v26, 16, v101
    v_and_b32 v27, 0xffff0000, v101
    v_lshlrev_b32 v28, 16, v102
    v_and_b32 v29, 0xffff0000, v102
    v_lshlrev_b32 v30, 16, v103
    v_and_b32 v31, 0xffff0000, v103
    v_add_f32 v16, v16, v104
    v_add_f32 v17, v17, v105
    v_add_f32 v18, v18, v106
    v_add_f32 v19, v19, v107
    v_add_f32 v20, v20, v108
    v_add_f32 v21, v21, v109
    v_add_f32 v22, v22, v110
    v_add_f32 v23, v23, v111
    v_add_f32 v24, v24, v112
    v_add_f32 v25, v25, v113
    v_add_f32 v26, v26, v114
    v_add_f32 v27, v27, v115
    v_add_f32 v28, v28, v116
    v_add_f32 v29, v29, v117
    v_add_f32 v30, v30, v118
    v_add_f32 v31, v31, v119
    v_cvt_pk_bf16_f32 v96, v16, v17
    v_cvt_pk_bf16_f32 v97, v18, v19
    v_cvt_pk_bf16_f32 v98, v20, v21
    v_cvt_pk_bf16_f32 v99, v22, v23
    v_cvt_pk_bf16_f32 v100, v24, v25
    v_cvt_pk_bf16_f32 v101, v26, v27
    v_cvt_pk_bf16_f32 v102, v28, v29
    v_cvt_pk_bf16_f32 v103, v30, v31
    buffer_store_dwordx4 v[96:99], v7, s[24:27], s36 offen
    buffer_store_dwordx4 v[100:103], v7, s[24:27], s36 offen offset:64
K3_FIN:
K3_END:
    s_endpgm
.section .rodata,"a"
.p2align 6
.amdhsa_kernel sequential_preLN__spectral_gfnet__glu_gated_glu__prompt_kernel
  .amdhsa_next_free_vgpr 512
  .amdhsa_next_free_sgpr 102
  .amdhsa_accum_offset 256
  .amdhsa_group_segment_fixed_size 0
  .amdhsa_kernarg_size 80
  .amdhsa_user_sgpr_count 2
  .amdhsa_user_sgpr_kernarg_segment_ptr 1
  .amdhsa_system_sgpr_workgroup_id_x 1
.end_amdhsa_kernel
```
